```python
import torch

def _softmax(x, axis=-1):
    return torch.softmax(x, dim=axis)
def _gelu(x):
    return torch.nn.functional.gelu(x, approximate="tanh")
def _silu(x):
    return torch.nn.functional.silu(x)
def _sigmoid(x):
    return torch.sigmoid(x)
def _layernorm(x, axis=-1, eps=1e-5):
    m = x.mean(dim=axis, keepdim=True)
    v = x.var(dim=axis, keepdim=True, unbiased=False)
    return (x - m) / torch.sqrt(v + eps)
def _scatter_add(tgt, idx, src, axis=0):
    return tgt.clone().index_add_(axis, idx, src)
def _segment_sum(src, seg, n):
    out = torch.zeros((n,) + src.shape[1:], dtype=src.dtype)
    return out.index_add_(0, seg, src)
def _pad(x, pw):
    flat = tuple(v for pair in reversed(pw) for v in pair)
    return torch.nn.functional.pad(x, flat)

kernel_name = 'gated_mix__mha_block__mha_block__prompt'

def setup_inputs():

    _w = (lambda a: (lambda t: t.to(torch.bfloat16) if t.is_floating_point() else t)(torch.as_tensor(a)))
    def _A_setup():
        B, S, D, H = 1, 2048, 448, 16
        return {
            "x": _w((lambda *s: torch.randn(*s, dtype=torch.bfloat16) * 0.05)(B, S, D)),
            "wqkv": _w((lambda *s: torch.randn(*s, dtype=torch.bfloat16) * 0.8)(D, 3 * D)),
            "wo": _w((lambda *s: torch.randn(*s, dtype=torch.bfloat16) * 0.05)(D, D)),
        }
    _A_in = _A_setup()

    def _B_setup():
        B, S, D, H = 1, 2048, 448, 16
        return {
            "x": _w((lambda *s: torch.randn(*s, dtype=torch.bfloat16) * 0.05)(B, S, D)),
            "wqkv": _w((lambda *s: torch.randn(*s, dtype=torch.bfloat16) * 0.8)(D, 3 * D)),
            "wo": _w((lambda *s: torch.randn(*s, dtype=torch.bfloat16) * 0.05)(D, D)),
        }
    _B_in = _B_setup()

    return {
        "A_x": _A_in["x"],
        "A_wqkv": _A_in["wqkv"],
        "A_wo": _A_in["wo"],
        "B_x": _B_in["x"],
        "B_wqkv": _B_in["wqkv"],
        "B_wo": _B_in["wo"],
        "gate_w": _w((lambda *s: torch.randn(*s, dtype=torch.bfloat16) * 0.05)(448) * 16.0),
    }

def reference(A_x, A_wqkv, A_wo, B_x, B_wqkv, B_wo, gate_w):
    def _A_ref(x, wqkv, wo):
        B, S, D = x.shape
        H = 16
        Dh = D // H
        qkv = (lambda x, *d: x.permute(*d))((x @ wqkv).reshape(B, S, 3, H, Dh), 2, 0, 3, 1, 4)
        q, k, v = qkv[0], qkv[1], qkv[2]
        scores = torch.einsum("bhqd,bhkd->bhqk", q, k) * (Dh ** -0.5)
        p = _softmax(scores, axis=-1)
        o = torch.einsum("bhqk,bhkd->bhqd", p, v)
        return (lambda x, *d: x.permute(*d))(o, 0, 2, 1, 3).reshape(B, S, D) @ wo

    def _B_ref(x, wqkv, wo):
        B, S, D = x.shape
        H = 16
        Dh = D // H
        qkv = (lambda x, *d: x.permute(*d))((x @ wqkv).reshape(B, S, 3, H, Dh), 2, 0, 3, 1, 4)
        q, k, v = qkv[0], qkv[1], qkv[2]
        scores = torch.einsum("bhqd,bhkd->bhqk", q, k) * (Dh ** -0.5)
        p = _softmax(scores, axis=-1)
        o = torch.einsum("bhqk,bhkd->bhqd", p, v)
        return (lambda x, *d: x.permute(*d))(o, 0, 2, 1, 3).reshape(B, S, D) @ wo

    x = A_x
    g = _sigmoid((x * gate_w).sum(-1, keepdims=True))
    a = _A_ref(x, A_wqkv, A_wo)
    b = _B_ref(x, B_wqkv, B_wo)
    return g * a + (1 - g) * b
```

```asm
; @launch grid=(256,1,1) block=(512,1,1) lds=163840
.amdgcn_target "amdgcn-amd-amdhsa--gfx950"
.text
.globl gated_mix__mha_block__mha_block__prompt_kernel
.p2align 8
.type gated_mix__mha_block__mha_block__prompt_kernel,@function
gated_mix__mha_block__mha_block__prompt_kernel:
    s_cmp_ge_u32 s2, 256
    s_cbranch_scc1 L_end
    s_load_dwordx16 s[4:19], s[0:1], 0
    s_load_dwordx2 s[36:37], s[0:1], 72
    s_and_b32 s40, s2, 3
    s_lshl_b32 s40, s40, 3
    s_lshr_b32 s41, s2, 3
    s_and_b32 s43, s41, 7
    s_add_u32 s40, s40, s43
    s_lshr_b32 s41, s41, 3
    s_lshl_b32 s52, s41, 1
    s_add_u32 s52, s52, s43
    s_and_b32 s43, s2, 4
    s_add_u32 s41, s41, s43
    v_lshrrev_b32 v1, 6, v0
    v_and_b32 v0, 63, v0
    v_readfirstlane_b32 s42, v1
    s_and_b32 s44, s40, 15
    s_mul_i32 s45, s44, 56
    v_lshrrev_b32 v2, 2, v0
    v_mul_u32_u24 v2, 2688, v2
    v_and_b32 v3, 3, v0
    v_lshl_add_u32 v2, v3, 4, v2
    v_add_u32 v2, s45, v2
    v_lshrrev_b32 v3, 3, v0
    v_mul_u32_u24 v4, 896, v3
    v_lshrrev_b32 v5, 4, v0
    v_and_b32 v6, 7, v0
    v_xor_b32 v7, v6, v5
    v_lshl_add_u32 v3, v7, 4, v4
    v_xor_b32 v7, 4, v7
    v_lshl_add_u32 v4, v7, 4, v4
    s_lshl_b32 s46, s41, 8
    s_lshl_b32 s47, s42, 5
    s_add_u32 s46, s46, s47
    s_mul_i32 s47, s46, 896
    s_lshl_b32 s48, s42, 12
    s_add_u32 s48, s48, 57344
    s_and_b32 s49, s42, 3
    s_mul_i32 s49, s49, 43008
    s_lshr_b32 s50, s42, 2
    s_mul_i32 s50, s50, 896
    s_add_u32 s50, s50, s49
    s_add_u32 s50, s50, 896
    s_lshl_b32 s51, s42, 10
    s_cmp_ge_u32 s52, 7
    s_cselect_b32 s53, 7, 0
    s_sub_u32 s52, s52, s53
    s_mov_b32 s39, s52
    s_waitcnt lgkmcnt(0)
    s_cmp_ge_u32 s40, 16
    s_cselect_b32 s6, s12, s6
    s_cselect_b32 s7, s13, s7
    s_mov_b32 s20, s4
    s_mov_b32 s21, s5
    s_mov_b32 s22, 1835008
    s_mov_b32 s23, 0x00020000
    s_mov_b32 s24, s6
    s_mov_b32 s25, s7
    s_mov_b32 s26, 1204224
    s_mov_b32 s27, 0x00020000
    s_mov_b32 s28, s36
    s_mov_b32 s29, s37
    s_mov_b32 s30, 268435456
    s_mov_b32 s31, 0x00020000
    s_mov_b32 s32, s16
    s_mov_b32 s33, s17
    s_mov_b32 s34, 896
    s_mov_b32 s35, 0x00020000
    s_add_u32 m0, s51, 0
    s_mul_i32 s53, s52, 172032
    s_add_u32 s53, s53, s50
    buffer_load_dwordx4 v2, s[24:27], s53 offen lds
    s_lshl_b32 s54, s52, 7
    s_add_u32 s54, s54, s47
    s_add_u32 s52, s52, 1
    s_cmp_eq_u32 s52, 7
    s_cselect_b32 s52, 0, s52
    s_add_u32 m0, s48, 0
    s_add_u32 s53, s54, 0
    buffer_load_dwordx4 v3, s[20:23], s53 offen lds
    s_add_u32 m0, s48, 1024
    s_add_u32 s53, s54, 7168
    buffer_load_dwordx4 v4, s[20:23], s53 offen lds
    s_add_u32 m0, s48, 2048
    s_add_u32 s53, s54, 14336
    buffer_load_dwordx4 v3, s[20:23], s53 offen lds
    s_add_u32 m0, s48, 3072
    s_add_u32 s53, s54, 21504
    buffer_load_dwordx4 v4, s[20:23], s53 offen lds
    v_lshlrev_b32 v5, 4, v0
    v_mov_b32 v9, 0x7ff00000
    v_cmp_gt_u32 vcc, 56, v0
    v_mov_b32 v31, 0
    s_nop 0
    v_cndmask_b32 v9, v9, v5, vcc
    s_lshl_b32 s55, s41, 8
    s_lshl_b32 s56, s40, 3
    s_add_u32 s55, s55, s56
    s_add_u32 s55, s55, s42
    s_mul_i32 s56, s55, 896
    s_mov_b32 s53, 12976128
    buffer_load_dword v104, v31, s[28:31], s53 offen sc1
    buffer_load_dwordx4 v[96:99], v9, s[20:23], s56 offen
    buffer_load_dwordx4 v[100:103], v9, s[32:35], 0 offen
    v_and_b32 v8, 31, v0
    v_lshrrev_b32 v19, 5, v0
    v_lshrrev_b32 v10, 1, v8
    v_and_b32 v10, 7, v10
    v_lshlrev_b32 v11, 7, v8
    v_add_u32 v11, s48, v11
    v_add_u32 v16, 0, v19
    v_xor_b32 v16, v16, v10
    v_lshl_add_u32 v12, v16, 4, v11
    v_add_u32 v24, 65536, v12
    v_add_u32 v16, 2, v19
    v_xor_b32 v16, v16, v10
    v_lshl_add_u32 v13, v16, 4, v11
    v_add_u32 v25, 65536, v13
    v_add_u32 v16, 4, v19
    v_xor_b32 v16, v16, v10
    v_lshl_add_u32 v14, v16, 4, v11
    v_add_u32 v26, 65536, v14
    v_add_u32 v16, 6, v19
    v_xor_b32 v16, v16, v10
    v_lshl_add_u32 v15, v16, 4, v11
    v_add_u32 v27, 65536, v15
    v_lshrrev_b32 v16, 2, v0
    v_and_b32 v16, 3, v16
    v_lshl_add_u32 v16, v19, 3, v16
    v_lshlrev_b32 v16, 6, v16
    v_lshrrev_b32 v17, 4, v0
    v_and_b32 v17, 1, v17
    v_lshl_add_u32 v16, v17, 5, v16
    v_and_b32 v17, 3, v0
    v_lshl_add_u32 v16, v17, 3, v16
    v_and_b32 v17, 30, v8
    v_cmp_eq_u32 vcc, 28, v17
    v_mov_b32 v18, 0x3f803f80
    v_mov_b32 v246, 0
    v_mov_b32 v247, 0
    v_cndmask_b32 v248, v31, v18, vcc
    v_cndmask_b32 v249, v31, v18, vcc
    v_cndmask_b32 v250, v31, v18, vcc
    v_cndmask_b32 v251, v31, v18, vcc
    v_cndmask_b32 v252, v31, v18, vcc
    v_cndmask_b32 v253, v31, v18, vcc
    v_cndmask_b32 v254, v31, v18, vcc
    v_cndmask_b32 v255, v31, v18, vcc
    v_and_b32 v21, 0x33, v0
    v_and_b32 v22, 4, v0
    v_lshl_or_b32 v21, v22, 1, v21
    v_and_b32 v22, 8, v0
    v_lshrrev_b32 v22, 1, v22
    v_or_b32 v21, v21, v22
    v_lshlrev_b32 v21, 4, v21
    s_lshr_b32 s58, s46, 5
    s_lshl_b32 s59, s40, 6
    s_add_u32 s58, s58, s59
    s_lshl_b32 s59, s58, 12
    s_lshl_b32 s58, s42, 12
    s_add_u32 s58, s58, 98304
    v_add_u32 v23, s58, v21
    v_cmp_le_u32 vcc, 11, v8
    s_nop 1
    v_addc_co_u32 v9, vcc, 0, v8, vcc
    v_cmp_le_u32 vcc, 14, v8
    s_nop 1
    v_addc_co_u32 v9, vcc, 0, v9, vcc
    v_cmp_le_u32 vcc, 25, v8
    s_nop 1
    v_addc_co_u32 v9, vcc, 0, v9, vcc
    v_and_b32 v10, 1, v8
    v_lshl_add_u32 v10, v10, 2, 11
    v_and_b32 v11, 2, v8
    v_lshl_add_u32 v10, v11, 3, v10
    v_cmp_le_u32 vcc, 28, v8
    s_nop 1
    v_cndmask_b32 v9, v9, v10, vcc
    v_lshl_add_u32 v9, v19, 5, v9
    v_lshlrev_b32 v9, 4, v9
    v_add_u32 v22, s58, v9
    s_mov_b32 s100, 0x3e8b97f6
    s_mov_b32 s101, s100
    s_and_b32 s44, s42, 3
    s_lshr_b32 s45, s42, 2
    s_lshl_b32 s46, s40, 18
    s_lshl_b32 s58, s45, 14
    s_add_u32 s58, s58, 65536
    v_add_u32 v28, s58, v5
    v_add_u32 v29, 65536, v28
    s_lshl_b32 s58, s42, 11
    s_add_u32 s58, s58, 32768
    v_add_u32 v6, s58, v5
    s_lshl_b32 s58, s44, 1
    s_add_u32 s58, s58, s45
    s_lshl_b32 s58, s58, 11
    s_add_u32 s58, s58, 32768
    v_add_u32 v7, s58, v5
    v_lshlrev_b32 v8, 7, v0
    v_mov_b32 v1, 0xdddddddd
    v_lshrrev_b32 v10, 3, v0
    v_mul_u32_u24 v11, 896, v10
    v_and_b32 v17, 7, v0
    v_and_b32 v10, 2, v10
    v_lshlrev_b32 v10, 1, v10
    v_xor_b32 v17, v17, v10
    v_lshl_add_u32 v30, v17, 4, v11
    v_mov_b32 v105, 0
    v_mov_b32 v106, 0
    v_mov_b32 v107, 0
    v_mov_b32 v108, 0
    v_mov_b32 v109, 0
    v_mov_b32 v110, 0
    v_mov_b32 v111, 0
    v_mov_b32 v112, 0
    v_mov_b32 v113, 0
    v_mov_b32 v114, 0
    v_mov_b32 v115, 0
    v_mov_b32 v116, 0
    v_mov_b32 v117, 0
    v_mov_b32 v118, 0
    v_mov_b32 v119, 0
    v_mov_b32 v120, 0
    v_mov_b32 v121, 0
    v_mov_b32 v122, 0
    v_mov_b32 v123, 0
    v_mov_b32 v124, 0
    v_mov_b32 v125, 0
    v_mov_b32 v126, 0
    v_mov_b32 v127, 0
    s_barrier
    s_add_u32 m0, s51, 8192
    s_mul_i32 s53, s52, 172032
    s_add_u32 s53, s53, s50
    buffer_load_dwordx4 v2, s[24:27], s53 offen lds
    s_lshl_b32 s54, s52, 7
    s_add_u32 s54, s54, s47
    s_add_u32 s52, s52, 1
    s_cmp_eq_u32 s52, 7
    s_cselect_b32 s52, 0, s52
    s_add_u32 m0, s48, 32768
    s_add_u32 s53, s54, 0
    buffer_load_dwordx4 v3, s[20:23], s53 offen lds
    s_add_u32 m0, s48, 33792
    s_add_u32 s53, s54, 7168
    buffer_load_dwordx4 v4, s[20:23], s53 offen lds
    s_add_u32 m0, s48, 34816
    s_add_u32 s53, s54, 14336
    buffer_load_dwordx4 v3, s[20:23], s53 offen lds
    s_add_u32 m0, s48, 35840
    s_add_u32 s53, s54, 21504
    buffer_load_dwordx4 v4, s[20:23], s53 offen lds
    s_waitcnt vmcnt(8)
    ds_read_b128 v[128:131], v12 offset:0
    ds_read_b128 v[132:135], v13 offset:0
    ds_read_b128 v[136:139], v14 offset:0
    ds_read_b128 v[140:143], v15 offset:0
    s_barrier
    ds_read_b64_tr_b16 v[80:81], v16 offset:0
    ds_read_b64_tr_b16 v[82:83], v16 offset:256
    ds_read_b64_tr_b16 v[84:85], v16 offset:4096
    ds_read_b64_tr_b16 v[86:87], v16 offset:4352
    ds_read_b64_tr_b16 v[88:89], v16 offset:1024
    ds_read_b64_tr_b16 v[90:91], v16 offset:1280
    ds_read_b64_tr_b16 v[92:93], v16 offset:5120
    ds_read_b64_tr_b16 v[94:95], v16 offset:5376
    s_waitcnt lgkmcnt(4)
    v_mfma_f32_32x32x16_bf16 v[64:79], v[128:131], v[84:87], 0
    v_mfma_f32_32x32x16_bf16 v[48:63], v[80:83], v[128:131], 0
    s_add_u32 m0, s51, 16384
    s_mul_i32 s53, s52, 172032
    s_add_u32 s53, s53, s50
    buffer_load_dwordx4 v2, s[24:27], s53 offen lds
    s_lshl_b32 s54, s52, 7
    s_add_u32 s54, s54, s47
    s_add_u32 s52, s52, 1
    s_cmp_eq_u32 s52, 7
    s_cselect_b32 s52, 0, s52
    s_add_u32 m0, s48, 65536
    s_add_u32 s53, s54, 0
    buffer_load_dwordx4 v3, s[20:23], s53 offen lds
    ds_read_b64_tr_b16 v[80:81], v16 offset:2048
    ds_read_b64_tr_b16 v[82:83], v16 offset:2304
    ds_read_b64_tr_b16 v[84:85], v16 offset:6144
    ds_read_b64_tr_b16 v[86:87], v16 offset:6400
    s_waitcnt lgkmcnt(4)
    v_mfma_f32_32x32x16_bf16 v[64:79], v[132:135], v[92:95], v[64:79]
    v_mfma_f32_32x32x16_bf16 v[48:63], v[88:91], v[132:135], v[48:63]
    s_add_u32 m0, s48, 66560
    s_add_u32 s53, s54, 7168
    buffer_load_dwordx4 v4, s[20:23], s53 offen lds
    ds_read_b64_tr_b16 v[88:89], v16 offset:3072
    ds_read_b64_tr_b16 v[90:91], v16 offset:3328
    ds_read_b64_tr_b16 v[92:93], v16 offset:7168
    ds_read_b64_tr_b16 v[94:95], v16 offset:7424
    s_waitcnt lgkmcnt(4)
    v_mfma_f32_32x32x16_bf16 v[64:79], v[136:139], v[84:87], v[64:79]
    v_mfma_f32_32x32x16_bf16 v[48:63], v[80:83], v[136:139], v[48:63]
    s_add_u32 m0, s48, 67584
    s_add_u32 s53, s54, 14336
    buffer_load_dwordx4 v3, s[20:23], s53 offen lds
    s_waitcnt lgkmcnt(0)
    v_mfma_f32_32x32x16_bf16 v[64:79], v[140:143], v[92:95], v[64:79]
    v_mfma_f32_32x32x16_bf16 v[48:63], v[88:91], v[140:143], v[48:63]
    s_add_u32 m0, s48, 68608
    s_add_u32 s53, s54, 21504
    buffer_load_dwordx4 v4, s[20:23], s53 offen lds
    s_waitcnt vmcnt(5)
    ds_read_b128 v[144:147], v12 offset:32768
    ds_read_b128 v[148:151], v13 offset:32768
    ds_read_b128 v[152:155], v14 offset:32768
    ds_read_b128 v[156:159], v15 offset:32768
    s_barrier
    ds_read_b64_tr_b16 v[80:81], v16 offset:8192
    ds_read_b64_tr_b16 v[82:83], v16 offset:8448
    ds_read_b64_tr_b16 v[84:85], v16 offset:12288
    ds_read_b64_tr_b16 v[86:87], v16 offset:12544
    ds_read_b64_tr_b16 v[88:89], v16 offset:9216
    ds_read_b64_tr_b16 v[90:91], v16 offset:9472
    ds_read_b64_tr_b16 v[92:93], v16 offset:13312
    ds_read_b64_tr_b16 v[94:95], v16 offset:13568
    s_waitcnt lgkmcnt(4)
    v_mfma_f32_32x32x16_bf16 v[64:79], v[144:147], v[84:87], v[64:79]
    v_mfma_f32_32x32x16_bf16 v[48:63], v[80:83], v[144:147], v[48:63]
    s_add_u32 m0, s51, 24576
    s_mul_i32 s53, s52, 172032
    s_add_u32 s53, s53, s50
    buffer_load_dwordx4 v2, s[24:27], s53 offen lds
    s_lshl_b32 s54, s52, 7
    s_add_u32 s54, s54, s47
    s_add_u32 s52, s52, 1
    s_cmp_eq_u32 s52, 7
    s_cselect_b32 s52, 0, s52
    s_add_u32 m0, s48, 0
    s_add_u32 s53, s54, 0
    buffer_load_dwordx4 v3, s[20:23], s53 offen lds
    v_mov_b32 v20, 0
    v_lshlrev_b32 v18, 16, v96
    v_lshlrev_b32 v19, 16, v100
    v_fmac_f32 v20, v18, v19
    ds_read_b64_tr_b16 v[80:81], v16 offset:10240
    ds_read_b64_tr_b16 v[82:83], v16 offset:10496
    ds_read_b64_tr_b16 v[84:85], v16 offset:14336
    ds_read_b64_tr_b16 v[86:87], v16 offset:14592
    s_waitcnt lgkmcnt(4)
    v_mfma_f32_32x32x16_bf16 v[64:79], v[148:151], v[92:95], v[64:79]
    v_mfma_f32_32x32x16_bf16 v[48:63], v[88:91], v[148:151], v[48:63]
    s_add_u32 m0, s48, 1024
    s_add_u32 s53, s54, 7168
    buffer_load_dwordx4 v4, s[20:23], s53 offen lds
    v_and_b32 v18, 0xffff0000, v96
    v_and_b32 v19, 0xffff0000, v100
    v_fmac_f32 v20, v18, v19
    v_lshlrev_b32 v18, 16, v97
    ds_read_b64_tr_b16 v[88:89], v16 offset:11264
    ds_read_b64_tr_b16 v[90:91], v16 offset:11520
    ds_read_b64_tr_b16 v[92:93], v16 offset:15360
    ds_read_b64_tr_b16 v[94:95], v16 offset:15616
    s_waitcnt lgkmcnt(4)
    v_mfma_f32_32x32x16_bf16 v[64:79], v[152:155], v[84:87], v[64:79]
    v_mfma_f32_32x32x16_bf16 v[48:63], v[80:83], v[152:155], v[48:63]
    s_add_u32 m0, s48, 2048
    s_add_u32 s53, s54, 14336
    buffer_load_dwordx4 v3, s[20:23], s53 offen lds
    v_lshlrev_b32 v19, 16, v101
    v_fmac_f32 v20, v18, v19
    v_and_b32 v18, 0xffff0000, v97
    v_and_b32 v19, 0xffff0000, v101
    s_waitcnt lgkmcnt(0)
    v_mfma_f32_32x32x16_bf16 v[64:79], v[156:159], v[92:95], v[64:79]
    v_mfma_f32_32x32x16_bf16 v[48:63], v[88:91], v[156:159], v[48:63]
    s_add_u32 m0, s48, 3072
    s_add_u32 s53, s54, 21504
    buffer_load_dwordx4 v4, s[20:23], s53 offen lds
    v_fmac_f32 v20, v18, v19
    v_lshlrev_b32 v18, 16, v98
    v_lshlrev_b32 v19, 16, v102
    v_fmac_f32 v20, v18, v19
    s_waitcnt vmcnt(5)
    ds_read_b128 v[160:163], v24 offset:0
    ds_read_b128 v[164:167], v25 offset:0
    ds_read_b128 v[168:171], v26 offset:0
    ds_read_b128 v[172:175], v27 offset:0
    s_barrier
    ds_read_b64_tr_b16 v[80:81], v16 offset:16384
    ds_read_b64_tr_b16 v[82:83], v16 offset:16640
    ds_read_b64_tr_b16 v[84:85], v16 offset:20480
    ds_read_b64_tr_b16 v[86:87], v16 offset:20736
    ds_read_b64_tr_b16 v[88:89], v16 offset:17408
    ds_read_b64_tr_b16 v[90:91], v16 offset:17664
    ds_read_b64_tr_b16 v[92:93], v16 offset:21504
    ds_read_b64_tr_b16 v[94:95], v16 offset:21760
    s_waitcnt lgkmcnt(4)
    v_mfma_f32_32x32x16_bf16 v[64:79], v[160:163], v[84:87], v[64:79]
    v_mfma_f32_32x32x16_bf16 v[48:63], v[80:83], v[160:163], v[48:63]
    s_add_u32 m0, s51, 32768
    s_mul_i32 s53, s52, 172032
    s_add_u32 s53, s53, s50
    buffer_load_dwordx4 v2, s[24:27], s53 offen lds
    s_lshl_b32 s54, s52, 7
    s_add_u32 s54, s54, s47
    s_add_u32 s52, s52, 1
    s_cmp_eq_u32 s52, 7
    s_cselect_b32 s52, 0, s52
    s_add_u32 m0, s48, 32768
    s_add_u32 s53, s54, 0
    buffer_load_dwordx4 v3, s[20:23], s53 offen lds
    v_and_b32 v18, 0xffff0000, v98
    v_and_b32 v19, 0xffff0000, v102
    v_fmac_f32 v20, v18, v19
    v_lshlrev_b32 v18, 16, v99
    ds_read_b64_tr_b16 v[80:81], v16 offset:18432
    ds_read_b64_tr_b16 v[82:83], v16 offset:18688
    ds_read_b64_tr_b16 v[84:85], v16 offset:22528
    ds_read_b64_tr_b16 v[86:87], v16 offset:22784
    s_waitcnt lgkmcnt(4)
    v_mfma_f32_32x32x16_bf16 v[64:79], v[164:167], v[92:95], v[64:79]
    v_mfma_f32_32x32x16_bf16 v[48:63], v[88:91], v[164:167], v[48:63]
    s_add_u32 m0, s48, 33792
    s_add_u32 s53, s54, 7168
    buffer_load_dwordx4 v4, s[20:23], s53 offen lds
    v_lshlrev_b32 v19, 16, v103
    v_fmac_f32 v20, v18, v19
    v_and_b32 v18, 0xffff0000, v99
    v_and_b32 v19, 0xffff0000, v103
    ds_read_b64_tr_b16 v[88:89], v16 offset:19456
    ds_read_b64_tr_b16 v[90:91], v16 offset:19712
    ds_read_b64_tr_b16 v[92:93], v16 offset:23552
    ds_read_b64_tr_b16 v[94:95], v16 offset:23808
    s_waitcnt lgkmcnt(4)
    v_mfma_f32_32x32x16_bf16 v[64:79], v[168:171], v[84:87], v[64:79]
    v_mfma_f32_32x32x16_bf16 v[48:63], v[80:83], v[168:171], v[48:63]
    s_add_u32 m0, s48, 34816
    s_add_u32 s53, s54, 14336
    buffer_load_dwordx4 v3, s[20:23], s53 offen lds
    v_fmac_f32 v20, v18, v19
    v_mov_b32 v96, 0
    v_mov_b32 v97, 0
    v_add_f32_dpp v20, v20, v20 row_shr:1 row_mask:0xf bank_mask:0xf bound_ctrl:0
    s_waitcnt lgkmcnt(0)
    v_mfma_f32_32x32x16_bf16 v[64:79], v[172:175], v[92:95], v[64:79]
    v_mfma_f32_32x32x16_bf16 v[48:63], v[88:91], v[172:175], v[48:63]
    s_add_u32 m0, s48, 35840
    s_add_u32 s53, s54, 21504
    buffer_load_dwordx4 v4, s[20:23], s53 offen lds
    v_mov_b32 v98, 0
    v_mov_b32 v99, 0
    v_add_f32_dpp v20, v20, v20 row_shr:2 row_mask:0xf bank_mask:0xf bound_ctrl:0
    v_mov_b32 v100, 0
    v_mov_b32 v101, 0
    v_add_f32_dpp v20, v20, v20 row_shr:4 row_mask:0xf bank_mask:0xf bound_ctrl:0
    s_waitcnt vmcnt(5)
    ds_read_b128 v[176:179], v12 offset:0
    ds_read_b128 v[180:183], v13 offset:0
    ds_read_b128 v[184:187], v14 offset:0
    ds_read_b128 v[188:191], v15 offset:0
    s_barrier
    ds_read_b64_tr_b16 v[80:81], v16 offset:24576
    ds_read_b64_tr_b16 v[82:83], v16 offset:24832
    ds_read_b64_tr_b16 v[84:85], v16 offset:28672
    ds_read_b64_tr_b16 v[86:87], v16 offset:28928
    ds_read_b64_tr_b16 v[88:89], v16 offset:25600
    ds_read_b64_tr_b16 v[90:91], v16 offset:25856
    ds_read_b64_tr_b16 v[92:93], v16 offset:29696
    ds_read_b64_tr_b16 v[94:95], v16 offset:29952
    s_waitcnt lgkmcnt(4)
    v_mfma_f32_32x32x16_bf16 v[64:79], v[176:179], v[84:87], v[64:79]
    v_mfma_f32_32x32x16_bf16 v[48:63], v[80:83], v[176:179], v[48:63]
    s_add_u32 m0, s51, 40960
    s_mul_i32 s53, s52, 172032
    s_add_u32 s53, s53, s50
    buffer_load_dwordx4 v2, s[24:27], s53 offen lds
    s_lshl_b32 s54, s52, 7
    s_add_u32 s54, s54, s47
    s_add_u32 s52, s52, 1
    s_cmp_eq_u32 s52, 7
    s_cselect_b32 s52, 0, s52
    s_add_u32 m0, s48, 65536
    s_add_u32 s53, s54, 0
    buffer_load_dwordx4 v3, s[20:23], s53 offen lds
    v_mov_b32 v102, 0
    v_mov_b32 v103, 0
    v_add_f32_dpp v20, v20, v20 row_shr:8 row_mask:0xf bank_mask:0xf bound_ctrl:0
    v_readfirstlane_b32 s67, v104
    v_mov_b32 v104, 0
    v_readlane_b32 s60, v20, 15
    v_readlane_b32 s61, v20, 31
    v_readlane_b32 s62, v20, 47
    v_readlane_b32 s63, v20, 63
    ds_read_b64_tr_b16 v[80:81], v16 offset:26624
    ds_read_b64_tr_b16 v[82:83], v16 offset:26880
    ds_read_b64_tr_b16 v[84:85], v16 offset:30720
    ds_read_b64_tr_b16 v[86:87], v16 offset:30976
    s_waitcnt lgkmcnt(4)
    v_mfma_f32_32x32x16_bf16 v[64:79], v[180:183], v[92:95], v[64:79]
    v_mfma_f32_32x32x16_bf16 v[48:63], v[88:91], v[180:183], v[48:63]
    s_add_u32 m0, s48, 66560
    s_add_u32 s53, s54, 7168
    buffer_load_dwordx4 v4, s[20:23], s53 offen lds
    s_mul_i32 s67, s67, 0x41c64e6d
    s_add_u32 s67, s67, 0x3039
    v_mov_b32 v20, s60
    v_add_f32 v20, s61, v20
    v_add_f32 v20, s62, v20
    v_add_f32 v20, s63, v20
    ds_read_b64_tr_b16 v[88:89], v16 offset:27648
    ds_read_b64_tr_b16 v[90:91], v16 offset:27904
    ds_read_b64_tr_b16 v[92:93], v16 offset:31744
    ds_read_b64_tr_b16 v[94:95], v16 offset:32000
    s_waitcnt lgkmcnt(4)
    v_mfma_f32_32x32x16_bf16 v[64:79], v[184:187], v[84:87], v[64:79]
    v_mfma_f32_32x32x16_bf16 v[48:63], v[80:83], v[184:187], v[48:63]
    s_add_u32 m0, s48, 67584
    s_add_u32 s53, s54, 14336
    buffer_load_dwordx4 v3, s[20:23], s53 offen lds
    v_mul_f32 v20, 0xbfb8aa3b, v20
    v_exp_f32 v20, v20
    s_lshl_b32 s55, s55, 3
    v_add_f32 v20, 1.0, v20
    v_rcp_f32 v18, v20
    s_add_u32 s55, s55, 12910592
    v_mov_b32 v20, s67
    v_mov_b32 v19, s67
    s_waitcnt lgkmcnt(0)
    v_mfma_f32_32x32x16_bf16 v[64:79], v[188:191], v[92:95], v[64:79]
    v_mfma_f32_32x32x16_bf16 v[48:63], v[88:91], v[188:191], v[48:63]
    s_add_u32 m0, s48, 68608
    s_add_u32 s53, s54, 21504
    buffer_load_dwordx4 v4, s[20:23], s53 offen lds
    s_lshr_b32 s62, s2, 3
    s_mul_i32 s61, s62, 0x2493
    s_lshr_b32 s61, s61, 16
    s_mul_i32 s63, s61, 7
    s_sub_u32 s62, s62, s63
    s_mul_i32 s63, s42, 7168
    s_lshl_b32 s64, s62, 7
    s_add_u32 s63, s63, s64
    s_waitcnt vmcnt(5)
    ds_read_b128 v[192:195], v12 offset:32768
    ds_read_b128 v[196:199], v13 offset:32768
    ds_read_b128 v[200:203], v14 offset:32768
    ds_read_b128 v[204:207], v15 offset:32768
    s_barrier
    ds_read_b64_tr_b16 v[80:81], v16 offset:32768
    ds_read_b64_tr_b16 v[82:83], v16 offset:33024
    ds_read_b64_tr_b16 v[84:85], v16 offset:36864
    ds_read_b64_tr_b16 v[86:87], v16 offset:37120
    ds_read_b64_tr_b16 v[88:89], v16 offset:33792
    ds_read_b64_tr_b16 v[90:91], v16 offset:34048
    ds_read_b64_tr_b16 v[92:93], v16 offset:37888
    ds_read_b64_tr_b16 v[94:95], v16 offset:38144
    s_waitcnt lgkmcnt(4)
    v_mfma_f32_32x32x16_bf16 v[64:79], v[192:195], v[84:87], v[64:79]
    v_mfma_f32_32x32x16_bf16 v[48:63], v[80:83], v[192:195], v[48:63]
    s_add_u32 m0, s51, 49152
    s_mul_i32 s53, s52, 172032
    s_add_u32 s53, s53, s50
    buffer_load_dwordx4 v2, s[24:27], s53 offen lds
    s_lshl_b32 s54, s52, 7
    s_add_u32 s54, s54, s47
    s_add_u32 s52, s52, 1
    s_cmp_eq_u32 s52, 7
    s_cselect_b32 s52, 0, s52
    s_add_u32 m0, s48, 0
    s_add_u32 s53, s54, 0
    buffer_load_dwordx4 v3, s[20:23], s53 offen lds
    ds_read_b64_tr_b16 v[80:81], v16 offset:34816
    ds_read_b64_tr_b16 v[82:83], v16 offset:35072
    ds_read_b64_tr_b16 v[84:85], v16 offset:38912
    ds_read_b64_tr_b16 v[86:87], v16 offset:39168
    s_waitcnt lgkmcnt(4)
    v_mfma_f32_32x32x16_bf16 v[64:79], v[196:199], v[92:95], v[64:79]
    v_mfma_f32_32x32x16_bf16 v[48:63], v[88:91], v[196:199], v[48:63]
    s_add_u32 m0, s48, 1024
    s_add_u32 s53, s54, 7168
    buffer_load_dwordx4 v4, s[20:23], s53 offen lds
    ds_read_b64_tr_b16 v[88:89], v16 offset:35840
    ds_read_b64_tr_b16 v[90:91], v16 offset:36096
    ds_read_b64_tr_b16 v[92:93], v16 offset:39936
    ds_read_b64_tr_b16 v[94:95], v16 offset:40192
    s_waitcnt lgkmcnt(4)
    v_mfma_f32_32x32x16_bf16 v[64:79], v[200:203], v[84:87], v[64:79]
    v_mfma_f32_32x32x16_bf16 v[48:63], v[80:83], v[200:203], v[48:63]
    s_add_u32 m0, s48, 2048
    s_add_u32 s53, s54, 14336
    buffer_load_dwordx4 v3, s[20:23], s53 offen lds
    s_waitcnt lgkmcnt(0)
    v_mfma_f32_32x32x16_bf16 v[64:79], v[204:207], v[92:95], v[64:79]
    v_mfma_f32_32x32x16_bf16 v[48:63], v[88:91], v[204:207], v[48:63]
    s_add_u32 m0, s48, 3072
    s_add_u32 s53, s54, 21504
    buffer_load_dwordx4 v4, s[20:23], s53 offen lds
    s_waitcnt vmcnt(5)
    ds_read_b128 v[208:211], v24 offset:0
    ds_read_b128 v[212:215], v25 offset:0
    ds_read_b128 v[216:219], v26 offset:0
    ds_read_b128 v[220:223], v27 offset:0
    s_barrier
    ds_read_b64_tr_b16 v[80:81], v16 offset:40960
    ds_read_b64_tr_b16 v[82:83], v16 offset:41216
    ds_read_b64_tr_b16 v[84:85], v16 offset:45056
    ds_read_b64_tr_b16 v[86:87], v16 offset:45312
    ds_read_b64_tr_b16 v[88:89], v16 offset:41984
    ds_read_b64_tr_b16 v[90:91], v16 offset:42240
    ds_read_b64_tr_b16 v[92:93], v16 offset:46080
    ds_read_b64_tr_b16 v[94:95], v16 offset:46336
    s_waitcnt lgkmcnt(4)
    v_mfma_f32_32x32x16_bf16 v[64:79], v[208:211], v[84:87], v[64:79]
    v_mfma_f32_32x32x16_bf16 v[48:63], v[80:83], v[208:211], v[48:63]
    s_lshr_b32 s53, s42, 2
    s_add_u32 s53, s53, s39
    s_add_u32 s53, s53, 0
    s_cmp_ge_u32 s53, 7
    s_cselect_b32 s54, 7, 0
    s_sub_u32 s53, s53, s54
    s_mul_i32 s53, s53, 172032
    s_add_u32 s53, s53, s49
    s_add_u32 m0, s51, 0
    s_nop 0
    buffer_load_dwordx4 v2, s[24:27], s53 offen lds
    ds_read_b64_tr_b16 v[80:81], v16 offset:43008
    ds_read_b64_tr_b16 v[82:83], v16 offset:43264
    ds_read_b64_tr_b16 v[84:85], v16 offset:47104
    ds_read_b64_tr_b16 v[86:87], v16 offset:47360
    s_waitcnt lgkmcnt(4)
    v_mfma_f32_32x32x16_bf16 v[64:79], v[212:215], v[92:95], v[64:79]
    v_mfma_f32_32x32x16_bf16 v[48:63], v[88:91], v[212:215], v[48:63]
    ds_read_b64_tr_b16 v[88:89], v16 offset:44032
    ds_read_b64_tr_b16 v[90:91], v16 offset:44288
    ds_read_b64_tr_b16 v[92:93], v16 offset:48128
    ds_read_b64_tr_b16 v[94:95], v16 offset:48384
    s_waitcnt lgkmcnt(4)
    v_mfma_f32_32x32x16_bf16 v[64:79], v[216:219], v[84:87], v[64:79]
    v_mfma_f32_32x32x16_bf16 v[48:63], v[80:83], v[216:219], v[48:63]
    s_lshr_b32 s53, s42, 2
    s_add_u32 s53, s53, s39
    s_add_u32 s53, s53, 2
    s_cmp_ge_u32 s53, 7
    s_cselect_b32 s54, 7, 0
    s_sub_u32 s53, s53, s54
    s_mul_i32 s53, s53, 172032
    s_add_u32 s53, s53, s49
    s_add_u32 m0, s51, 8192
    s_nop 0
    buffer_load_dwordx4 v2, s[24:27], s53 offen lds
    s_waitcnt lgkmcnt(0)
    v_mfma_f32_32x32x16_bf16 v[64:79], v[220:223], v[92:95], v[64:79]
    v_mfma_f32_32x32x16_bf16 v[48:63], v[88:91], v[220:223], v[48:63]
    s_waitcnt vmcnt(2)
    ds_read_b128 v[224:227], v12 offset:0
    ds_read_b128 v[228:231], v13 offset:0
    ds_read_b128 v[232:235], v14 offset:0
    ds_read_b128 v[236:239], v15 offset:0
    s_barrier
    ds_read_b64_tr_b16 v[80:81], v16 offset:49152
    ds_read_b64_tr_b16 v[82:83], v16 offset:49408
    ds_read_b64_tr_b16 v[84:85], v16 offset:53248
    ds_read_b64_tr_b16 v[86:87], v16 offset:53504
    ds_read_b64_tr_b16 v[88:89], v16 offset:50176
    ds_read_b64_tr_b16 v[90:91], v16 offset:50432
    ds_read_b64_tr_b16 v[92:93], v16 offset:54272
    ds_read_b64_tr_b16 v[94:95], v16 offset:54528
    s_waitcnt lgkmcnt(4)
    v_mfma_f32_32x32x16_bf16 v[64:79], v[224:227], v[84:87], v[64:79]
    v_mfma_f32_32x32x16_bf16 v[48:63], v[80:83], v[224:227], v[48:63]
    s_lshr_b32 s53, s42, 2
    s_add_u32 s53, s53, s39
    s_add_u32 s53, s53, 4
    s_cmp_ge_u32 s53, 7
    s_cselect_b32 s54, 7, 0
    s_sub_u32 s53, s53, s54
    s_mul_i32 s53, s53, 172032
    s_add_u32 s53, s53, s49
    s_add_u32 m0, s51, 16384
    s_nop 0
    buffer_load_dwordx4 v2, s[24:27], s53 offen lds
    ds_read_b64_tr_b16 v[80:81], v16 offset:51200
    ds_read_b64_tr_b16 v[82:83], v16 offset:51456
    ds_read_b64_tr_b16 v[84:85], v16 offset:55296
    ds_read_b64_tr_b16 v[86:87], v16 offset:55552
    s_waitcnt lgkmcnt(4)
    v_mfma_f32_32x32x16_bf16 v[64:79], v[228:231], v[92:95], v[64:79]
    v_mfma_f32_32x32x16_bf16 v[48:63], v[88:91], v[228:231], v[48:63]
    ds_read_b64_tr_b16 v[88:89], v16 offset:52224
    ds_read_b64_tr_b16 v[90:91], v16 offset:52480
    ds_read_b64_tr_b16 v[92:93], v16 offset:56320
    ds_read_b64_tr_b16 v[94:95], v16 offset:56576
    s_waitcnt lgkmcnt(4)
    v_mfma_f32_32x32x16_bf16 v[64:79], v[232:235], v[84:87], v[64:79]
    v_mfma_f32_32x32x16_bf16 v[48:63], v[80:83], v[232:235], v[48:63]
    s_waitcnt lgkmcnt(0)
    v_mfma_f32_32x32x16_bf16 v[64:79], v[236:239], v[92:95], v[64:79]
    v_mfma_f32_32x32x16_bf16 v[48:63], v[88:91], v[236:239], v[48:63]
    s_mov_b64 exec, 1
    buffer_store_dwordx2 v[18:19], v31, s[28:31], s55 offen sc1
    s_mov_b64 exec, -1
    s_nop 6
    s_mov_b32 exec_lo, 0x0fffffff
    s_mov_b32 exec_hi, 0x0fffffff
    v_cvt_pk_bf16_f32 v248, v64, v65
    v_cvt_pk_bf16_f32 v249, v66, v67
    v_cvt_pk_bf16_f32 v250, v68, v69
    v_cvt_pk_bf16_f32 v251, v70, v71
    s_mov_b64 exec, -1
    s_mov_b32 exec_lo, 0x0fffffff
    s_mov_b32 exec_hi, 0x0fffffff
    v_cvt_pk_bf16_f32 v252, v72, v73
    v_cvt_pk_bf16_f32 v253, v74, v75
    v_cvt_pk_bf16_f32 v254, v76, v77
    v_cvt_pk_bf16_f32 v255, v78, v79
    s_mov_b64 exec, -1
    buffer_store_dwordx4 v[248:251], v9, s[28:31], s59 offen offset:2048 sc1
    buffer_store_dwordx4 v[252:255], v9, s[28:31], s59 offen offset:3072 sc1
    v_pk_mul_f32 v[48:49], v[48:49], s[100:101]
    v_pk_mul_f32 v[50:51], v[50:51], s[100:101]
    v_pk_mul_f32 v[52:53], v[52:53], s[100:101]
    v_pk_mul_f32 v[54:55], v[54:55], s[100:101]
    v_pk_mul_f32 v[56:57], v[56:57], s[100:101]
    v_pk_mul_f32 v[58:59], v[58:59], s[100:101]
    v_pk_mul_f32 v[60:61], v[60:61], s[100:101]
    v_pk_mul_f32 v[62:63], v[62:63], s[100:101]
    v_cvt_pk_bf16_f32 v240, v48, v49
    v_cvt_pk_bf16_f32 v241, v50, v51
    v_cvt_pk_bf16_f32 v242, v52, v53
    v_cvt_pk_bf16_f32 v243, v54, v55
    v_cvt_pk_bf16_f32 v244, v56, v57
    v_cvt_pk_bf16_f32 v245, v58, v59
    s_mov_b32 exec_hi, 0
    v_cvt_pk_bf16_f32 v246, v60, v61
    v_cvt_pk_bf16_f32 v247, v62, v63
    s_mov_b64 exec, -1
    buffer_store_dwordx4 v[240:243], v21, s[28:31], s59 offen sc1
    buffer_store_dwordx4 v[244:247], v21, s[28:31], s59 offen offset:1024 sc1
    s_lshr_b32 s53, s42, 2
    s_add_u32 s53, s53, s39
    s_add_u32 s53, s53, 6
    s_cmp_ge_u32 s53, 7
    s_cselect_b32 s54, 7, 0
    s_sub_u32 s53, s53, s54
    s_mul_i32 s53, s53, 172032
    s_add_u32 s53, s53, s49
    s_cmp_ge_u32 s42, 4
    s_cselect_b32 s53, 0x7ff00000, s53
    s_add_u32 m0, s51, 24576
    s_nop 0
    buffer_load_dwordx4 v2, s[24:27], s53 offen lds
    s_lshl_b32 s47, s45, 14
    s_lshl_b32 s48, s44, 10
    s_add_u32 s47, s47, s48
    s_add_u32 s49, s46, s47
    s_cmp_lt_u32 s2, 224
    s_cselect_b32 s22, 401408, 0
    s_mov_b32 s20, s8
    s_mov_b32 s21, s9
    s_mov_b32 s24, s14
    s_mov_b32 s25, s15
    s_mov_b32 s26, s22
    ds_write_b128 v23, v[240:243]
    ds_write_b128 v23, v[244:247] offset:1024
    ds_write_b128 v22, v[248:251] offset:2048
    ds_write_b128 v22, v[252:255] offset:3072
    s_waitcnt vmcnt(7)
    s_barrier
    ds_read_b64_tr_b16 v[80:81], v16 offset:0
    ds_read_b64_tr_b16 v[82:83], v16 offset:256
    ds_read_b64_tr_b16 v[84:85], v16 offset:1024
    ds_read_b64_tr_b16 v[86:87], v16 offset:1280
    ds_read_b64_tr_b16 v[88:89], v16 offset:2048
    ds_read_b64_tr_b16 v[90:91], v16 offset:2304
    s_waitcnt lgkmcnt(4)
    v_mfma_f32_32x32x16_bf16 v[32:47], v[80:83], v[128:131], 0
    ds_read_b64_tr_b16 v[92:93], v16 offset:3072
    ds_read_b64_tr_b16 v[94:95], v16 offset:3328
    s_waitcnt lgkmcnt(4)
    v_mfma_f32_32x32x16_bf16 v[32:47], v[84:87], v[132:135], v[32:47]
    ds_read_b64_tr_b16 v[80:81], v16 offset:4096
    ds_read_b64_tr_b16 v[82:83], v16 offset:4352
    s_waitcnt lgkmcnt(4)
    v_mfma_f32_32x32x16_bf16 v[32:47], v[88:91], v[136:139], v[32:47]
    ds_read_b64_tr_b16 v[84:85], v16 offset:5120
    ds_read_b64_tr_b16 v[86:87], v16 offset:5376
    s_waitcnt lgkmcnt(4)
    v_mfma_f32_32x32x16_bf16 v[32:47], v[92:95], v[140:143], v[32:47]
    ds_read_b64_tr_b16 v[88:89], v16 offset:6144
    ds_read_b64_tr_b16 v[90:91], v16 offset:6400
    s_waitcnt lgkmcnt(4)
    v_mfma_f32_32x32x16_bf16 v[32:47], v[80:83], v[144:147], v[32:47]
    ds_read_b64_tr_b16 v[92:93], v16 offset:7168
    ds_read_b64_tr_b16 v[94:95], v16 offset:7424
    s_waitcnt lgkmcnt(4)
    v_mfma_f32_32x32x16_bf16 v[32:47], v[84:87], v[148:151], v[32:47]
    ds_read_b64_tr_b16 v[80:81], v16 offset:8192
    ds_read_b64_tr_b16 v[82:83], v16 offset:8448
    s_waitcnt lgkmcnt(4)
    v_mfma_f32_32x32x16_bf16 v[32:47], v[88:91], v[152:155], v[32:47]
    ds_read_b64_tr_b16 v[84:85], v16 offset:9216
    ds_read_b64_tr_b16 v[86:87], v16 offset:9472
    s_waitcnt lgkmcnt(4)
    v_mfma_f32_32x32x16_bf16 v[32:47], v[92:95], v[156:159], v[32:47]
    ds_read_b64_tr_b16 v[88:89], v16 offset:10240
    ds_read_b64_tr_b16 v[90:91], v16 offset:10496
    s_waitcnt lgkmcnt(4)
    v_mfma_f32_32x32x16_bf16 v[32:47], v[80:83], v[160:163], v[32:47]
    ds_read_b64_tr_b16 v[92:93], v16 offset:11264
    ds_read_b64_tr_b16 v[94:95], v16 offset:11520
    s_waitcnt lgkmcnt(4)
    v_mfma_f32_32x32x16_bf16 v[32:47], v[84:87], v[164:167], v[32:47]
    ds_read_b64_tr_b16 v[80:81], v16 offset:12288
    ds_read_b64_tr_b16 v[82:83], v16 offset:12544
    s_waitcnt lgkmcnt(4)
    v_mfma_f32_32x32x16_bf16 v[32:47], v[88:91], v[168:171], v[32:47]
    ds_read_b64_tr_b16 v[84:85], v16 offset:13312
    ds_read_b64_tr_b16 v[86:87], v16 offset:13568
    s_waitcnt lgkmcnt(4)
    v_mfma_f32_32x32x16_bf16 v[32:47], v[92:95], v[172:175], v[32:47]
    ds_read_b64_tr_b16 v[88:89], v16 offset:14336
    ds_read_b64_tr_b16 v[90:91], v16 offset:14592
    s_waitcnt lgkmcnt(4)
    v_mfma_f32_32x32x16_bf16 v[32:47], v[80:83], v[176:179], v[32:47]
    ds_read_b64_tr_b16 v[92:93], v16 offset:15360
    ds_read_b64_tr_b16 v[94:95], v16 offset:15616
    s_waitcnt lgkmcnt(4)
    v_mfma_f32_32x32x16_bf16 v[32:47], v[84:87], v[180:183], v[32:47]
    s_waitcnt lgkmcnt(2)
    v_mfma_f32_32x32x16_bf16 v[32:47], v[88:91], v[184:187], v[32:47]
    s_waitcnt lgkmcnt(0)
    v_mfma_f32_32x32x16_bf16 v[32:47], v[92:95], v[188:191], v[32:47]
    s_waitcnt vmcnt(0)
    s_barrier
    s_cmp_lg_u32 s42, 0
    s_cbranch_scc1 L_nopub
    s_lshl_b32 s53, s40, 3
    s_add_u32 s53, s53, s41
    s_lshl_b32 s53, s53, 7
    s_add_u32 s53, s53, 12845056
    s_mov_b64 exec, 1
    buffer_store_dword v20, v31, s[28:31], s53 offen sc1
    s_mov_b64 exec, -1
L_nopub:
    ds_read_b64_tr_b16 v[80:81], v16 offset:16384
    ds_read_b64_tr_b16 v[82:83], v16 offset:16640
    ds_read_b64_tr_b16 v[84:85], v16 offset:17408
    ds_read_b64_tr_b16 v[86:87], v16 offset:17664
    ds_read_b64_tr_b16 v[88:89], v16 offset:18432
    ds_read_b64_tr_b16 v[90:91], v16 offset:18688
    s_waitcnt lgkmcnt(4)
    v_mfma_f32_32x32x16_bf16 v[32:47], v[80:83], v[192:195], v[32:47]
    ds_read_b64_tr_b16 v[92:93], v16 offset:19456
    ds_read_b64_tr_b16 v[94:95], v16 offset:19712
    s_waitcnt lgkmcnt(4)
    v_mfma_f32_32x32x16_bf16 v[32:47], v[84:87], v[196:199], v[32:47]
    ds_read_b64_tr_b16 v[80:81], v16 offset:20480
    ds_read_b64_tr_b16 v[82:83], v16 offset:20736
    s_waitcnt lgkmcnt(4)
    v_mfma_f32_32x32x16_bf16 v[32:47], v[88:91], v[200:203], v[32:47]
    ds_read_b64_tr_b16 v[84:85], v16 offset:21504
    ds_read_b64_tr_b16 v[86:87], v16 offset:21760
    s_waitcnt lgkmcnt(4)
    v_mfma_f32_32x32x16_bf16 v[32:47], v[92:95], v[204:207], v[32:47]
    ds_read_b64_tr_b16 v[88:89], v16 offset:22528
    ds_read_b64_tr_b16 v[90:91], v16 offset:22784
    s_waitcnt lgkmcnt(4)
    v_mfma_f32_32x32x16_bf16 v[32:47], v[80:83], v[208:211], v[32:47]
    ds_read_b64_tr_b16 v[92:93], v16 offset:23552
    ds_read_b64_tr_b16 v[94:95], v16 offset:23808
    s_waitcnt lgkmcnt(4)
    v_mfma_f32_32x32x16_bf16 v[32:47], v[84:87], v[212:215], v[32:47]
    ds_read_b64_tr_b16 v[80:81], v16 offset:24576
    ds_read_b64_tr_b16 v[82:83], v16 offset:24832
    s_waitcnt lgkmcnt(4)
    v_mfma_f32_32x32x16_bf16 v[32:47], v[88:91], v[216:219], v[32:47]
    ds_read_b64_tr_b16 v[84:85], v16 offset:25600
    ds_read_b64_tr_b16 v[86:87], v16 offset:25856
    s_waitcnt lgkmcnt(4)
    v_mfma_f32_32x32x16_bf16 v[32:47], v[92:95], v[220:223], v[32:47]
    ds_read_b64_tr_b16 v[88:89], v16 offset:26624
    ds_read_b64_tr_b16 v[90:91], v16 offset:26880
    s_waitcnt lgkmcnt(4)
    v_mfma_f32_32x32x16_bf16 v[32:47], v[80:83], v[224:227], v[32:47]
    ds_read_b64_tr_b16 v[92:93], v16 offset:27648
    ds_read_b64_tr_b16 v[94:95], v16 offset:27904
    s_waitcnt lgkmcnt(4)
    v_mfma_f32_32x32x16_bf16 v[32:47], v[84:87], v[228:231], v[32:47]
    s_waitcnt lgkmcnt(2)
    v_mfma_f32_32x32x16_bf16 v[32:47], v[88:91], v[232:235], v[32:47]
    s_waitcnt lgkmcnt(0)
    v_mfma_f32_32x32x16_bf16 v[32:47], v[92:95], v[236:239], v[32:47]
    s_nop 11
    v_cvt_pk_bf16_f32 v80, v32, v33
    v_cvt_pk_bf16_f32 v81, v34, v35
    v_cvt_pk_bf16_f32 v82, v36, v37
    v_cvt_pk_bf16_f32 v83, v38, v39
    v_cvt_pk_bf16_f32 v84, v40, v41
    v_cvt_pk_bf16_f32 v85, v42, v43
    v_cvt_pk_bf16_f32 v86, v44, v45
    v_cvt_pk_bf16_f32 v87, v46, v47
    s_mov_b32 exec_lo, 0
    v_mov_b32 v86, 0
    v_mov_b32 v87, 0
    s_mov_b64 exec, -1
    ds_write_b128 v6, v[80:83]
    ds_write_b128 v6, v[84:87] offset:1024
    s_lshl_b32 s53, s45, 2
    s_add_u32 s53, s53, 57344
    v_mov_b32 v24, s53
    v_xor_b32 v6, 2048, v7
    v_mov_b32 v25, 1
    ds_write_b32 v24, v31
    s_waitcnt lgkmcnt(0)
    s_barrier
    ds_read_b128 v[128:131], v6 offset:0
    ds_read_b128 v[132:135], v6 offset:1024
    ds_read_b128 v[136:139], v7 offset:0
    ds_read_b128 v[140:143], v7 offset:1024
    ds_read_b128 v[144:147], v28 offset:32768
    ds_read_b128 v[148:151], v28 offset:33792
    s_waitcnt lgkmcnt(0)
    v_mfma_f32_32x32x16_bf16 v[32:47], v[144:147], v[128:131], 0
    v_mfma_f32_32x32x16_bf16 v[32:47], v[148:151], v[132:135], v[32:47]
    s_nop 15
    s_lshl_b32 s53, s40, 10
    s_add_u32 s53, s53, 12845056
    s_mov_b64 exec, 0xff
    buffer_load_dword v9, v8, s[28:31], s53 offen sc1
    s_mov_b64 exec, -1
    ds_read_b128 v[152:155], v28 offset:36864
    ds_read_b128 v[156:159], v28 offset:37888
    ds_read_b128 v[160:163], v28 offset:34816
    ds_read_b128 v[164:167], v28 offset:35840
    s_setprio 2
    v_mfma_f32_32x32x16_bf16 v[48:63], v[144:147], v[136:139], 0
    v_exp_f32 v32, v32
    v_exp_f32 v33, v33
    v_exp_f32 v34, v34
    v_exp_f32 v35, v35
    v_mfma_f32_32x32x16_bf16 v[48:63], v[148:151], v[140:143], v[48:63]
    v_exp_f32 v36, v36
    v_exp_f32 v37, v37
    v_exp_f32 v38, v38
    v_exp_f32 v39, v39
    v_exp_f32 v40, v40
    v_exp_f32 v41, v41
    v_exp_f32 v42, v42
    v_exp_f32 v43, v43
    v_exp_f32 v44, v44
    v_exp_f32 v45, v45
    v_exp_f32 v46, v46
    v_exp_f32 v47, v47
    s_waitcnt lgkmcnt(0)
    v_mfma_f32_32x32x16_bf16 v[64:79], v[152:155], v[128:131], 0
    v_exp_f32 v48, v48
    v_exp_f32 v49, v49
    v_exp_f32 v50, v50
    v_exp_f32 v51, v51
    v_mfma_f32_32x32x16_bf16 v[64:79], v[156:159], v[132:135], v[64:79]
    v_exp_f32 v52, v52
    v_exp_f32 v53, v53
    v_exp_f32 v54, v54
    v_exp_f32 v55, v55
    v_smfmac_f32_32x32x32_bf16 v[96:111], v[160:163], v[32:39], v1
    v_exp_f32 v56, v56
    v_exp_f32 v57, v57
    v_exp_f32 v58, v58
    v_exp_f32 v59, v59
    v_smfmac_f32_32x32x32_bf16 v[96:111], v[164:167], v[40:47], v1
    v_exp_f32 v60, v60
    v_exp_f32 v61, v61
    v_exp_f32 v62, v62
    v_exp_f32 v63, v63
    s_lshl_b32 s53, s40, 10
    s_add_u32 s53, s53, 12845056
    s_and_b32 s54, s41, 4
    s_lshl_b32 s54, 15, s54
    s_bitset0_b32 s54, s41
    s_mov_b32 s55, 0
    s_waitcnt vmcnt(0)
    v_cmp_ne_u32 vcc, s67, v9
    s_and_b32 s52, s54, vcc_lo
    s_cbranch_scc0 L_poll1_x
    s_mov_b32 s60, 131072
    s_mov_b64 exec, s[54:55]
L_poll1:
    buffer_load_dword v9, v8, s[28:31], s53 offen sc1
    s_sub_u32 s60, s60, 1
    s_cbranch_scc1 L_poll1_x
    s_waitcnt vmcnt(0)
    v_cmp_ne_u32 vcc, s67, v9
    s_cbranch_vccnz L_poll1
L_poll1_x:
    s_mov_b64 exec, -1
    s_xor_b32 s50, s41, 1
    s_lshl_b32 s50, s50, 15
    s_add_u32 s50, s50, s49
    s_add_u32 m0, s47, 131072
    s_add_u32 s53, s50, 0
    buffer_load_dwordx4 v5, s[28:31], s53 offen sc1 lds
    s_add_u32 m0, s47, 135168
    s_add_u32 s53, s50, 4096
    buffer_load_dwordx4 v5, s[28:31], s53 offen sc1 lds
    s_add_u32 m0, s47, 139264
    s_add_u32 s53, s50, 8192
    buffer_load_dwordx4 v5, s[28:31], s53 offen sc1 lds
    s_add_u32 m0, s47, 143360
    s_add_u32 s53, s50, 12288
    buffer_load_dwordx4 v5, s[28:31], s53 offen sc1 lds
    ds_read_b128 v[144:147], v28 offset:40960
    ds_read_b128 v[148:151], v28 offset:41984
    ds_read_b128 v[168:171], v28 offset:38912
    ds_read_b128 v[172:175], v28 offset:39936
    s_setprio 1
    v_mfma_f32_32x32x16_bf16 v[80:95], v[152:155], v[136:139], 0
    v_exp_f32 v64, v64
    v_exp_f32 v65, v65
    v_exp_f32 v66, v66
    v_exp_f32 v67, v67
    v_mfma_f32_32x32x16_bf16 v[80:95], v[156:159], v[140:143], v[80:95]
    v_exp_f32 v68, v68
    v_exp_f32 v69, v69
    v_exp_f32 v70, v70
    v_exp_f32 v71, v71
    s_xor_b32 s50, s41, 2
    s_lshl_b32 s50, s50, 15
    s_add_u32 s50, s50, s49
    s_add_u32 m0, s47, 65536
    s_add_u32 s53, s50, 0
    buffer_load_dwordx4 v5, s[28:31], s53 offen sc1 lds
    v_smfmac_f32_32x32x32_bf16 v[112:127], v[160:163], v[48:55], v1
    v_exp_f32 v72, v72
    v_exp_f32 v73, v73
    v_exp_f32 v74, v74
    v_exp_f32 v75, v75
    v_smfmac_f32_32x32x32_bf16 v[112:127], v[164:167], v[56:63], v1
    v_exp_f32 v76, v76
    v_exp_f32 v77, v77
    v_exp_f32 v78, v78
    v_exp_f32 v79, v79
    s_add_u32 m0, s47, 69632
    s_add_u32 s53, s50, 4096
    buffer_load_dwordx4 v5, s[28:31], s53 offen sc1 lds
    s_waitcnt lgkmcnt(0)
    v_mfma_f32_32x32x16_bf16 v[32:47], v[144:147], v[128:131], 0
    v_exp_f32 v80, v80
    v_exp_f32 v81, v81
    v_exp_f32 v82, v82
    v_exp_f32 v83, v83
    v_mfma_f32_32x32x16_bf16 v[32:47], v[148:151], v[132:135], v[32:47]
    v_exp_f32 v84, v84
    v_exp_f32 v85, v85
    v_exp_f32 v86, v86
    v_exp_f32 v87, v87
    s_add_u32 m0, s47, 73728
    s_add_u32 s53, s50, 8192
    buffer_load_dwordx4 v5, s[28:31], s53 offen sc1 lds
    v_smfmac_f32_32x32x32_bf16 v[96:111], v[168:171], v[64:71], v1
    v_exp_f32 v88, v88
    v_exp_f32 v89, v89
    v_exp_f32 v90, v90
    v_exp_f32 v91, v91
    v_smfmac_f32_32x32x32_bf16 v[96:111], v[172:175], v[72:79], v1
    v_exp_f32 v92, v92
    v_exp_f32 v93, v93
    v_exp_f32 v94, v94
    v_exp_f32 v95, v95
    s_add_u32 m0, s47, 77824
    s_add_u32 s53, s50, 12288
    buffer_load_dwordx4 v5, s[28:31], s53 offen sc1 lds
    ds_read_b128 v[152:155], v28 offset:45056
    ds_read_b128 v[156:159], v28 offset:46080
    ds_read_b128 v[160:163], v28 offset:43008
    ds_read_b128 v[164:167], v28 offset:44032
    s_setprio 0
    v_mfma_f32_32x32x16_bf16 v[48:63], v[144:147], v[136:139], 0
    v_exp_f32 v32, v32
    v_exp_f32 v33, v33
    v_exp_f32 v34, v34
    v_exp_f32 v35, v35
    v_mfma_f32_32x32x16_bf16 v[48:63], v[148:151], v[140:143], v[48:63]
    v_exp_f32 v36, v36
    v_exp_f32 v37, v37
    v_exp_f32 v38, v38
    v_exp_f32 v39, v39
    v_smfmac_f32_32x32x32_bf16 v[112:127], v[168:171], v[80:87], v1
    v_exp_f32 v40, v40
    v_exp_f32 v41, v41
    v_exp_f32 v42, v42
    v_exp_f32 v43, v43
    v_smfmac_f32_32x32x32_bf16 v[112:127], v[172:175], v[88:95], v1
    v_exp_f32 v44, v44
    v_exp_f32 v45, v45
    v_exp_f32 v46, v46
    v_exp_f32 v47, v47
    s_waitcnt lgkmcnt(0)
    v_mfma_f32_32x32x16_bf16 v[64:79], v[152:155], v[128:131], 0
    v_exp_f32 v48, v48
    v_exp_f32 v49, v49
    v_exp_f32 v50, v50
    v_exp_f32 v51, v51
    v_mfma_f32_32x32x16_bf16 v[64:79], v[156:159], v[132:135], v[64:79]
    v_exp_f32 v52, v52
    v_exp_f32 v53, v53
    v_exp_f32 v54, v54
    v_exp_f32 v55, v55
    v_smfmac_f32_32x32x32_bf16 v[96:111], v[160:163], v[32:39], v1
    v_exp_f32 v56, v56
    v_exp_f32 v57, v57
    v_exp_f32 v58, v58
    v_exp_f32 v59, v59
    v_smfmac_f32_32x32x32_bf16 v[96:111], v[164:167], v[40:47], v1
    v_exp_f32 v60, v60
    v_exp_f32 v61, v61
    v_exp_f32 v62, v62
    v_exp_f32 v63, v63
    s_waitcnt vmcnt(4)
    s_barrier
    ds_read_b128 v[144:147], v29 offset:0
    ds_read_b128 v[148:151], v29 offset:1024
    ds_read_b128 v[168:171], v28 offset:47104
    ds_read_b128 v[172:175], v28 offset:48128
    s_setprio 3
    v_mfma_f32_32x32x16_bf16 v[80:95], v[152:155], v[136:139], 0
    v_exp_f32 v64, v64
    v_exp_f32 v65, v65
    v_exp_f32 v66, v66
    v_exp_f32 v67, v67
    v_mfma_f32_32x32x16_bf16 v[80:95], v[156:159], v[140:143], v[80:95]
    v_exp_f32 v68, v68
    v_exp_f32 v69, v69
    v_exp_f32 v70, v70
    v_exp_f32 v71, v71
    s_add_u32 m0, s51, 0
    s_add_u32 s53, s63, 0
    buffer_load_dwordx4 v30, s[20:23], s53 offen lds
    v_smfmac_f32_32x32x32_bf16 v[112:127], v[160:163], v[48:55], v1
    v_exp_f32 v72, v72
    v_exp_f32 v73, v73
    v_exp_f32 v74, v74
    v_exp_f32 v75, v75
    v_smfmac_f32_32x32x32_bf16 v[112:127], v[164:167], v[56:63], v1
    v_exp_f32 v76, v76
    v_exp_f32 v77, v77
    v_exp_f32 v78, v78
    v_exp_f32 v79, v79
    s_add_u32 m0, s51, 8192
    s_add_u32 s53, s63, 57344
    buffer_load_dwordx4 v30, s[20:23], s53 offen lds
    s_waitcnt lgkmcnt(0)
    v_mfma_f32_32x32x16_bf16 v[32:47], v[144:147], v[128:131], 0
    v_exp_f32 v80, v80
    v_exp_f32 v81, v81
    v_exp_f32 v82, v82
    v_exp_f32 v83, v83
    v_mfma_f32_32x32x16_bf16 v[32:47], v[148:151], v[132:135], v[32:47]
    v_exp_f32 v84, v84
    v_exp_f32 v85, v85
    v_exp_f32 v86, v86
    v_exp_f32 v87, v87
    v_smfmac_f32_32x32x32_bf16 v[96:111], v[168:171], v[64:71], v1
    v_exp_f32 v88, v88
    v_exp_f32 v89, v89
    v_exp_f32 v90, v90
    v_exp_f32 v91, v91
    v_smfmac_f32_32x32x32_bf16 v[96:111], v[172:175], v[72:79], v1
    v_exp_f32 v92, v92
    v_exp_f32 v93, v93
    v_exp_f32 v94, v94
    v_exp_f32 v95, v95
    ds_read_b128 v[152:155], v29 offset:4096
    ds_read_b128 v[156:159], v29 offset:5120
    ds_read_b128 v[160:163], v29 offset:2048
    ds_read_b128 v[164:167], v29 offset:3072
    s_setprio 2
    v_mfma_f32_32x32x16_bf16 v[48:63], v[144:147], v[136:139], 0
    v_exp_f32 v32, v32
    v_exp_f32 v33, v33
    v_exp_f32 v34, v34
    v_exp_f32 v35, v35
    v_mfma_f32_32x32x16_bf16 v[48:63], v[148:151], v[140:143], v[48:63]
    v_exp_f32 v36, v36
    v_exp_f32 v37, v37
    v_exp_f32 v38, v38
    v_exp_f32 v39, v39
    v_smfmac_f32_32x32x32_bf16 v[112:127], v[168:171], v[80:87], v1
    v_exp_f32 v40, v40
    v_exp_f32 v41, v41
    v_exp_f32 v42, v42
    v_exp_f32 v43, v43
    v_smfmac_f32_32x32x32_bf16 v[112:127], v[172:175], v[88:95], v1
    v_exp_f32 v44, v44
    v_exp_f32 v45, v45
    v_exp_f32 v46, v46
    v_exp_f32 v47, v47
    s_waitcnt lgkmcnt(0)
    v_mfma_f32_32x32x16_bf16 v[64:79], v[152:155], v[128:131], 0
    v_exp_f32 v48, v48
    v_exp_f32 v49, v49
    v_exp_f32 v50, v50
    v_exp_f32 v51, v51
    v_mfma_f32_32x32x16_bf16 v[64:79], v[156:159], v[132:135], v[64:79]
    v_exp_f32 v52, v52
    v_exp_f32 v53, v53
    v_exp_f32 v54, v54
    v_exp_f32 v55, v55
    v_smfmac_f32_32x32x32_bf16 v[96:111], v[160:163], v[32:39], v1
    v_exp_f32 v56, v56
    v_exp_f32 v57, v57
    v_exp_f32 v58, v58
    v_exp_f32 v59, v59
    v_smfmac_f32_32x32x32_bf16 v[96:111], v[164:167], v[40:47], v1
    v_exp_f32 v60, v60
    v_exp_f32 v61, v61
    v_exp_f32 v62, v62
    v_exp_f32 v63, v63
    ds_read_b128 v[144:147], v29 offset:8192
    ds_read_b128 v[148:151], v29 offset:9216
    ds_read_b128 v[168:171], v29 offset:6144
    ds_read_b128 v[172:175], v29 offset:7168
    s_setprio 1
    v_mfma_f32_32x32x16_bf16 v[80:95], v[152:155], v[136:139], 0
    v_exp_f32 v64, v64
    v_exp_f32 v65, v65
    v_exp_f32 v66, v66
    v_exp_f32 v67, v67
    v_mfma_f32_32x32x16_bf16 v[80:95], v[156:159], v[140:143], v[80:95]
    v_exp_f32 v68, v68
    v_exp_f32 v69, v69
    v_exp_f32 v70, v70
    v_exp_f32 v71, v71
    v_smfmac_f32_32x32x32_bf16 v[112:127], v[160:163], v[48:55], v1
    v_exp_f32 v72, v72
    v_exp_f32 v73, v73
    v_exp_f32 v74, v74
    v_exp_f32 v75, v75
    v_smfmac_f32_32x32x32_bf16 v[112:127], v[164:167], v[56:63], v1
    v_exp_f32 v76, v76
    v_exp_f32 v77, v77
    v_exp_f32 v78, v78
    v_exp_f32 v79, v79
    s_waitcnt lgkmcnt(0)
    v_mfma_f32_32x32x16_bf16 v[32:47], v[144:147], v[128:131], 0
    v_exp_f32 v80, v80
    v_exp_f32 v81, v81
    v_exp_f32 v82, v82
    v_exp_f32 v83, v83
    v_mfma_f32_32x32x16_bf16 v[32:47], v[148:151], v[132:135], v[32:47]
    v_exp_f32 v84, v84
    v_exp_f32 v85, v85
    v_exp_f32 v86, v86
    v_exp_f32 v87, v87
    v_smfmac_f32_32x32x32_bf16 v[96:111], v[168:171], v[64:71], v1
    v_exp_f32 v88, v88
    v_exp_f32 v89, v89
    v_exp_f32 v90, v90
    v_exp_f32 v91, v91
    v_smfmac_f32_32x32x32_bf16 v[96:111], v[172:175], v[72:79], v1
    v_exp_f32 v92, v92
    v_exp_f32 v93, v93
    v_exp_f32 v94, v94
    v_exp_f32 v95, v95
    ds_read_b128 v[152:155], v29 offset:12288
    ds_read_b128 v[156:159], v29 offset:13312
    ds_read_b128 v[160:163], v29 offset:10240
    ds_read_b128 v[164:167], v29 offset:11264
    s_setprio 0
    s_waitcnt vmcnt(2)
    s_mov_b64 exec, 1
    ds_add_u32 v24, v25
    s_mov_b64 exec, -1
    v_mfma_f32_32x32x16_bf16 v[48:63], v[144:147], v[136:139], 0
    v_exp_f32 v32, v32
    v_exp_f32 v33, v33
    v_exp_f32 v34, v34
    v_exp_f32 v35, v35
    v_mfma_f32_32x32x16_bf16 v[48:63], v[148:151], v[140:143], v[48:63]
    v_exp_f32 v36, v36
    v_exp_f32 v37, v37
    v_exp_f32 v38, v38
    v_exp_f32 v39, v39
    v_smfmac_f32_32x32x32_bf16 v[112:127], v[168:171], v[80:87], v1
    v_exp_f32 v40, v40
    v_exp_f32 v41, v41
    v_exp_f32 v42, v42
    v_exp_f32 v43, v43
    v_smfmac_f32_32x32x32_bf16 v[112:127], v[172:175], v[88:95], v1
    v_exp_f32 v44, v44
    v_exp_f32 v45, v45
    v_exp_f32 v46, v46
    v_exp_f32 v47, v47
    s_waitcnt lgkmcnt(0)
    v_mfma_f32_32x32x16_bf16 v[64:79], v[152:155], v[128:131], 0
    v_exp_f32 v48, v48
    v_exp_f32 v49, v49
    v_exp_f32 v50, v50
    v_exp_f32 v51, v51
    v_mfma_f32_32x32x16_bf16 v[64:79], v[156:159], v[132:135], v[64:79]
    v_exp_f32 v52, v52
    v_exp_f32 v53, v53
    v_exp_f32 v54, v54
    v_exp_f32 v55, v55
    v_smfmac_f32_32x32x32_bf16 v[96:111], v[160:163], v[32:39], v1
    v_exp_f32 v56, v56
    v_exp_f32 v57, v57
    v_exp_f32 v58, v58
    v_exp_f32 v59, v59
    ds_read_b32 v26, v24
    v_smfmac_f32_32x32x32_bf16 v[96:111], v[164:167], v[40:47], v1
    v_exp_f32 v60, v60
    v_exp_f32 v61, v61
    v_exp_f32 v62, v62
    v_exp_f32 v63, v63
L_s2:
    s_waitcnt lgkmcnt(0)
    v_cmp_gt_u32 vcc, 4, v26
    s_cbranch_vccz L_sx2
    ds_read_b32 v26, v24
    s_branch L_s2
L_sx2:
    ds_read_b128 v[144:147], v28 offset:0
    ds_read_b128 v[148:151], v28 offset:1024
    ds_read_b128 v[168:171], v29 offset:14336
    ds_read_b128 v[172:175], v29 offset:15360
    s_setprio 3
    v_mfma_f32_32x32x16_bf16 v[80:95], v[152:155], v[136:139], 0
    v_exp_f32 v64, v64
    v_exp_f32 v65, v65
    v_exp_f32 v66, v66
    v_exp_f32 v67, v67
    v_mfma_f32_32x32x16_bf16 v[80:95], v[156:159], v[140:143], v[80:95]
    v_exp_f32 v68, v68
    v_exp_f32 v69, v69
    v_exp_f32 v70, v70
    v_exp_f32 v71, v71
    s_xor_b32 s50, s41, 3
    s_lshl_b32 s50, s50, 15
    s_add_u32 s50, s50, s49
    s_add_u32 m0, s47, 98304
    s_add_u32 s53, s50, 0
    buffer_load_dwordx4 v5, s[28:31], s53 offen sc1 lds
    v_smfmac_f32_32x32x32_bf16 v[112:127], v[160:163], v[48:55], v1
    v_exp_f32 v72, v72
    v_exp_f32 v73, v73
    v_exp_f32 v74, v74
    v_exp_f32 v75, v75
    v_smfmac_f32_32x32x32_bf16 v[112:127], v[164:167], v[56:63], v1
    v_exp_f32 v76, v76
    v_exp_f32 v77, v77
    v_exp_f32 v78, v78
    v_exp_f32 v79, v79
    s_add_u32 m0, s47, 102400
    s_add_u32 s53, s50, 4096
    buffer_load_dwordx4 v5, s[28:31], s53 offen sc1 lds
    s_waitcnt lgkmcnt(0)
    v_mfma_f32_32x32x16_bf16 v[32:47], v[144:147], v[128:131], 0
    v_exp_f32 v80, v80
    v_exp_f32 v81, v81
    v_exp_f32 v82, v82
    v_exp_f32 v83, v83
    v_mfma_f32_32x32x16_bf16 v[32:47], v[148:151], v[132:135], v[32:47]
    v_exp_f32 v84, v84
    v_exp_f32 v85, v85
    v_exp_f32 v86, v86
    v_exp_f32 v87, v87
    s_add_u32 m0, s47, 106496
    s_add_u32 s53, s50, 8192
    buffer_load_dwordx4 v5, s[28:31], s53 offen sc1 lds
    v_smfmac_f32_32x32x32_bf16 v[96:111], v[168:171], v[64:71], v1
    v_exp_f32 v88, v88
    v_exp_f32 v89, v89
    v_exp_f32 v90, v90
    v_exp_f32 v91, v91
    v_smfmac_f32_32x32x32_bf16 v[96:111], v[172:175], v[72:79], v1
    v_exp_f32 v92, v92
    v_exp_f32 v93, v93
    v_exp_f32 v94, v94
    v_exp_f32 v95, v95
    s_add_u32 m0, s47, 110592
    s_add_u32 s53, s50, 12288
    buffer_load_dwordx4 v5, s[28:31], s53 offen sc1 lds
    ds_read_b128 v[152:155], v28 offset:4096
    ds_read_b128 v[156:159], v28 offset:5120
    ds_read_b128 v[160:163], v28 offset:2048
    ds_read_b128 v[164:167], v28 offset:3072
    s_setprio 2
    v_mfma_f32_32x32x16_bf16 v[48:63], v[144:147], v[136:139], 0
    v_exp_f32 v32, v32
    v_exp_f32 v33, v33
    v_exp_f32 v34, v34
    v_exp_f32 v35, v35
    v_mfma_f32_32x32x16_bf16 v[48:63], v[148:151], v[140:143], v[48:63]
    v_exp_f32 v36, v36
    v_exp_f32 v37, v37
    v_exp_f32 v38, v38
    v_exp_f32 v39, v39
    s_add_u32 m0, s51, 16384
    s_add_u32 s53, s63, 114688
    buffer_load_dwordx4 v30, s[20:23], s53 offen lds
    v_smfmac_f32_32x32x32_bf16 v[112:127], v[168:171], v[80:87], v1
    v_exp_f32 v40, v40
    v_exp_f32 v41, v41
    v_exp_f32 v42, v42
    v_exp_f32 v43, v43
    v_smfmac_f32_32x32x32_bf16 v[112:127], v[172:175], v[88:95], v1
    v_exp_f32 v44, v44
    v_exp_f32 v45, v45
    v_exp_f32 v46, v46
    v_exp_f32 v47, v47
    s_add_u32 m0, s51, 24576
    s_add_u32 s53, s63, 172032
    buffer_load_dwordx4 v30, s[20:23], s53 offen lds
    s_waitcnt lgkmcnt(0)
    v_mfma_f32_32x32x16_bf16 v[64:79], v[152:155], v[128:131], 0
    v_exp_f32 v48, v48
    v_exp_f32 v49, v49
    v_exp_f32 v50, v50
    v_exp_f32 v51, v51
    v_mfma_f32_32x32x16_bf16 v[64:79], v[156:159], v[132:135], v[64:79]
    v_exp_f32 v52, v52
    v_exp_f32 v53, v53
    v_exp_f32 v54, v54
    v_exp_f32 v55, v55
    s_lshl_b32 s53, s40, 10
    s_add_u32 s53, s53, 12845056
    s_mov_b64 exec, 0xff
    buffer_load_dword v9, v8, s[28:31], s53 offen sc1
    s_mov_b64 exec, -1
    v_smfmac_f32_32x32x32_bf16 v[96:111], v[160:163], v[32:39], v1
    v_exp_f32 v56, v56
    v_exp_f32 v57, v57
    v_exp_f32 v58, v58
    v_exp_f32 v59, v59
    v_smfmac_f32_32x32x32_bf16 v[96:111], v[164:167], v[40:47], v1
    v_exp_f32 v60, v60
    v_exp_f32 v61, v61
    v_exp_f32 v62, v62
    v_exp_f32 v63, v63
    ds_read_b128 v[144:147], v28 offset:8192
    ds_read_b128 v[148:151], v28 offset:9216
    ds_read_b128 v[168:171], v28 offset:6144
    ds_read_b128 v[172:175], v28 offset:7168
    s_setprio 1
    v_mfma_f32_32x32x16_bf16 v[80:95], v[152:155], v[136:139], 0
    v_exp_f32 v64, v64
    v_exp_f32 v65, v65
    v_exp_f32 v66, v66
    v_exp_f32 v67, v67
    v_mfma_f32_32x32x16_bf16 v[80:95], v[156:159], v[140:143], v[80:95]
    v_exp_f32 v68, v68
    v_exp_f32 v69, v69
    v_exp_f32 v70, v70
    v_exp_f32 v71, v71
    v_smfmac_f32_32x32x32_bf16 v[112:127], v[160:163], v[48:55], v1
    v_exp_f32 v72, v72
    v_exp_f32 v73, v73
    v_exp_f32 v74, v74
    v_exp_f32 v75, v75
    v_smfmac_f32_32x32x32_bf16 v[112:127], v[164:167], v[56:63], v1
    v_exp_f32 v76, v76
    v_exp_f32 v77, v77
    v_exp_f32 v78, v78
    v_exp_f32 v79, v79
    s_waitcnt lgkmcnt(0)
    v_mfma_f32_32x32x16_bf16 v[32:47], v[144:147], v[128:131], 0
    v_exp_f32 v80, v80
    v_exp_f32 v81, v81
    v_exp_f32 v82, v82
    v_exp_f32 v83, v83
    v_mfma_f32_32x32x16_bf16 v[32:47], v[148:151], v[132:135], v[32:47]
    v_exp_f32 v84, v84
    v_exp_f32 v85, v85
    v_exp_f32 v86, v86
    v_exp_f32 v87, v87
    v_smfmac_f32_32x32x32_bf16 v[96:111], v[168:171], v[64:71], v1
    v_exp_f32 v88, v88
    v_exp_f32 v89, v89
    v_exp_f32 v90, v90
    v_exp_f32 v91, v91
    v_smfmac_f32_32x32x32_bf16 v[96:111], v[172:175], v[72:79], v1
    v_exp_f32 v92, v92
    v_exp_f32 v93, v93
    v_exp_f32 v94, v94
    v_exp_f32 v95, v95
    ds_read_b128 v[152:155], v28 offset:12288
    ds_read_b128 v[156:159], v28 offset:13312
    ds_read_b128 v[160:163], v28 offset:10240
    ds_read_b128 v[164:167], v28 offset:11264
    s_setprio 0
    s_waitcnt vmcnt(3)
    s_mov_b64 exec, 1
    ds_add_u32 v24, v25
    s_mov_b64 exec, -1
    v_mfma_f32_32x32x16_bf16 v[48:63], v[144:147], v[136:139], 0
    v_exp_f32 v32, v32
    v_exp_f32 v33, v33
    v_exp_f32 v34, v34
    v_exp_f32 v35, v35
    v_mfma_f32_32x32x16_bf16 v[48:63], v[148:151], v[140:143], v[48:63]
    v_exp_f32 v36, v36
    v_exp_f32 v37, v37
    v_exp_f32 v38, v38
    v_exp_f32 v39, v39
    v_smfmac_f32_32x32x32_bf16 v[112:127], v[168:171], v[80:87], v1
    v_exp_f32 v40, v40
    v_exp_f32 v41, v41
    v_exp_f32 v42, v42
    v_exp_f32 v43, v43
    v_smfmac_f32_32x32x32_bf16 v[112:127], v[172:175], v[88:95], v1
    v_exp_f32 v44, v44
    v_exp_f32 v45, v45
    v_exp_f32 v46, v46
    v_exp_f32 v47, v47
    s_waitcnt lgkmcnt(0)
    v_mfma_f32_32x32x16_bf16 v[64:79], v[152:155], v[128:131], 0
    v_exp_f32 v48, v48
    v_exp_f32 v49, v49
    v_exp_f32 v50, v50
    v_exp_f32 v51, v51
    v_mfma_f32_32x32x16_bf16 v[64:79], v[156:159], v[132:135], v[64:79]
    v_exp_f32 v52, v52
    v_exp_f32 v53, v53
    v_exp_f32 v54, v54
    v_exp_f32 v55, v55
    v_smfmac_f32_32x32x32_bf16 v[96:111], v[160:163], v[32:39], v1
    v_exp_f32 v56, v56
    v_exp_f32 v57, v57
    v_exp_f32 v58, v58
    v_exp_f32 v59, v59
    ds_read_b32 v26, v24
    v_smfmac_f32_32x32x32_bf16 v[96:111], v[164:167], v[40:47], v1
    v_exp_f32 v60, v60
    v_exp_f32 v61, v61
    v_exp_f32 v62, v62
    v_exp_f32 v63, v63
L_s3:
    s_waitcnt lgkmcnt(0)
    v_cmp_gt_u32 vcc, 8, v26
    s_cbranch_vccz L_sx3
    ds_read_b32 v26, v24
    s_branch L_s3
L_sx3:
    s_waitcnt vmcnt(0)
    v_cmp_ne_u32 vcc, s67, v9
    s_and_b32 s52, vcc_lo, 0xff
    s_cbranch_scc0 L_poll2_x
    s_lshl_b32 s53, s40, 10
    s_add_u32 s53, s53, 12845056
    s_mov_b32 s60, 131072
    s_mov_b64 exec, 0xff
L_poll2:
    buffer_load_dword v9, v8, s[28:31], s53 offen sc1
    s_sub_u32 s60, s60, 1
    s_cbranch_scc1 L_poll2_x
    s_waitcnt vmcnt(0)
    v_cmp_ne_u32 vcc, s67, v9
    s_cbranch_vccnz L_poll2
L_poll2_x:
    s_mov_b64 exec, -1
    ds_read_b128 v[144:147], v28 offset:32768
    ds_read_b128 v[148:151], v28 offset:33792
    ds_read_b128 v[168:171], v28 offset:14336
    ds_read_b128 v[172:175], v28 offset:15360
    s_setprio 3
    v_mfma_f32_32x32x16_bf16 v[80:95], v[152:155], v[136:139], 0
    v_exp_f32 v64, v64
    v_exp_f32 v65, v65
    v_exp_f32 v66, v66
    v_exp_f32 v67, v67
    v_mfma_f32_32x32x16_bf16 v[80:95], v[156:159], v[140:143], v[80:95]
    v_exp_f32 v68, v68
    v_exp_f32 v69, v69
    v_exp_f32 v70, v70
    v_exp_f32 v71, v71
    s_xor_b32 s50, s41, 4
    s_lshl_b32 s50, s50, 15
    s_add_u32 s50, s50, s49
    s_add_u32 m0, s47, 131072
    s_add_u32 s53, s50, 0
    buffer_load_dwordx4 v5, s[28:31], s53 offen sc1 lds
    v_smfmac_f32_32x32x32_bf16 v[112:127], v[160:163], v[48:55], v1
    v_exp_f32 v72, v72
    v_exp_f32 v73, v73
    v_exp_f32 v74, v74
    v_exp_f32 v75, v75
    v_smfmac_f32_32x32x32_bf16 v[112:127], v[164:167], v[56:63], v1
    v_exp_f32 v76, v76
    v_exp_f32 v77, v77
    v_exp_f32 v78, v78
    v_exp_f32 v79, v79
    s_add_u32 m0, s47, 135168
    s_add_u32 s53, s50, 4096
    buffer_load_dwordx4 v5, s[28:31], s53 offen sc1 lds
    s_waitcnt lgkmcnt(0)
    v_mfma_f32_32x32x16_bf16 v[32:47], v[144:147], v[128:131], 0
    v_exp_f32 v80, v80
    v_exp_f32 v81, v81
    v_exp_f32 v82, v82
    v_exp_f32 v83, v83
    v_mfma_f32_32x32x16_bf16 v[32:47], v[148:151], v[132:135], v[32:47]
    v_exp_f32 v84, v84
    v_exp_f32 v85, v85
    v_exp_f32 v86, v86
    v_exp_f32 v87, v87
    s_add_u32 m0, s47, 139264
    s_add_u32 s53, s50, 8192
    buffer_load_dwordx4 v5, s[28:31], s53 offen sc1 lds
    v_smfmac_f32_32x32x32_bf16 v[96:111], v[168:171], v[64:71], v1
    v_exp_f32 v88, v88
    v_exp_f32 v89, v89
    v_exp_f32 v90, v90
    v_exp_f32 v91, v91
    v_smfmac_f32_32x32x32_bf16 v[96:111], v[172:175], v[72:79], v1
    v_exp_f32 v92, v92
    v_exp_f32 v93, v93
    v_exp_f32 v94, v94
    v_exp_f32 v95, v95
    s_add_u32 m0, s47, 143360
    s_add_u32 s53, s50, 12288
    buffer_load_dwordx4 v5, s[28:31], s53 offen sc1 lds
    ds_read_b128 v[152:155], v28 offset:36864
    ds_read_b128 v[156:159], v28 offset:37888
    ds_read_b128 v[160:163], v28 offset:34816
    ds_read_b128 v[164:167], v28 offset:35840
    s_setprio 2
    v_mfma_f32_32x32x16_bf16 v[48:63], v[144:147], v[136:139], 0
    v_exp_f32 v32, v32
    v_exp_f32 v33, v33
    v_exp_f32 v34, v34
    v_exp_f32 v35, v35
    v_mfma_f32_32x32x16_bf16 v[48:63], v[148:151], v[140:143], v[48:63]
    v_exp_f32 v36, v36
    v_exp_f32 v37, v37
    v_exp_f32 v38, v38
    v_exp_f32 v39, v39
    s_add_u32 m0, s51, 32768
    s_add_u32 s53, s63, 229376
    buffer_load_dwordx4 v30, s[20:23], s53 offen lds
    v_smfmac_f32_32x32x32_bf16 v[112:127], v[168:171], v[80:87], v1
    v_exp_f32 v40, v40
    v_exp_f32 v41, v41
    v_exp_f32 v42, v42
    v_exp_f32 v43, v43
    v_smfmac_f32_32x32x32_bf16 v[112:127], v[172:175], v[88:95], v1
    v_exp_f32 v44, v44
    v_exp_f32 v45, v45
    v_exp_f32 v46, v46
    v_exp_f32 v47, v47
    s_add_u32 m0, s51, 40960
    s_add_u32 s53, s63, 286720
    buffer_load_dwordx4 v30, s[20:23], s53 offen lds
    s_waitcnt lgkmcnt(0)
    v_mfma_f32_32x32x16_bf16 v[64:79], v[152:155], v[128:131], 0
    v_exp_f32 v48, v48
    v_exp_f32 v49, v49
    v_exp_f32 v50, v50
    v_exp_f32 v51, v51
    v_mfma_f32_32x32x16_bf16 v[64:79], v[156:159], v[132:135], v[64:79]
    v_exp_f32 v52, v52
    v_exp_f32 v53, v53
    v_exp_f32 v54, v54
    v_exp_f32 v55, v55
    v_smfmac_f32_32x32x32_bf16 v[96:111], v[160:163], v[32:39], v1
    v_exp_f32 v56, v56
    v_exp_f32 v57, v57
    v_exp_f32 v58, v58
    v_exp_f32 v59, v59
    v_smfmac_f32_32x32x32_bf16 v[96:111], v[164:167], v[40:47], v1
    v_exp_f32 v60, v60
    v_exp_f32 v61, v61
    v_exp_f32 v62, v62
    v_exp_f32 v63, v63
    ds_read_b128 v[144:147], v28 offset:40960
    ds_read_b128 v[148:151], v28 offset:41984
    ds_read_b128 v[168:171], v28 offset:38912
    ds_read_b128 v[172:175], v28 offset:39936
    s_setprio 1
    v_mfma_f32_32x32x16_bf16 v[80:95], v[152:155], v[136:139], 0
    v_exp_f32 v64, v64
    v_exp_f32 v65, v65
    v_exp_f32 v66, v66
    v_exp_f32 v67, v67
    v_mfma_f32_32x32x16_bf16 v[80:95], v[156:159], v[140:143], v[80:95]
    v_exp_f32 v68, v68
    v_exp_f32 v69, v69
    v_exp_f32 v70, v70
    v_exp_f32 v71, v71
    v_smfmac_f32_32x32x32_bf16 v[112:127], v[160:163], v[48:55], v1
    v_exp_f32 v72, v72
    v_exp_f32 v73, v73
    v_exp_f32 v74, v74
    v_exp_f32 v75, v75
    v_smfmac_f32_32x32x32_bf16 v[112:127], v[164:167], v[56:63], v1
    v_exp_f32 v76, v76
    v_exp_f32 v77, v77
    v_exp_f32 v78, v78
    v_exp_f32 v79, v79
    s_waitcnt lgkmcnt(0)
    v_mfma_f32_32x32x16_bf16 v[32:47], v[144:147], v[128:131], 0
    v_exp_f32 v80, v80
    v_exp_f32 v81, v81
    v_exp_f32 v82, v82
    v_exp_f32 v83, v83
    v_mfma_f32_32x32x16_bf16 v[32:47], v[148:151], v[132:135], v[32:47]
    v_exp_f32 v84, v84
    v_exp_f32 v85, v85
    v_exp_f32 v86, v86
    v_exp_f32 v87, v87
    v_smfmac_f32_32x32x32_bf16 v[96:111], v[168:171], v[64:71], v1
    v_exp_f32 v88, v88
    v_exp_f32 v89, v89
    v_exp_f32 v90, v90
    v_exp_f32 v91, v91
    v_smfmac_f32_32x32x32_bf16 v[96:111], v[172:175], v[72:79], v1
    v_exp_f32 v92, v92
    v_exp_f32 v93, v93
    v_exp_f32 v94, v94
    v_exp_f32 v95, v95
    ds_read_b128 v[152:155], v28 offset:45056
    ds_read_b128 v[156:159], v28 offset:46080
    ds_read_b128 v[160:163], v28 offset:43008
    ds_read_b128 v[164:167], v28 offset:44032
    s_setprio 0
    s_waitcnt vmcnt(2)
    s_mov_b64 exec, 1
    ds_add_u32 v24, v25
    s_mov_b64 exec, -1
    v_mfma_f32_32x32x16_bf16 v[48:63], v[144:147], v[136:139], 0
    v_exp_f32 v32, v32
    v_exp_f32 v33, v33
    v_exp_f32 v34, v34
    v_exp_f32 v35, v35
    v_mfma_f32_32x32x16_bf16 v[48:63], v[148:151], v[140:143], v[48:63]
    v_exp_f32 v36, v36
    v_exp_f32 v37, v37
    v_exp_f32 v38, v38
    v_exp_f32 v39, v39
    v_smfmac_f32_32x32x32_bf16 v[112:127], v[168:171], v[80:87], v1
    v_exp_f32 v40, v40
    v_exp_f32 v41, v41
    v_exp_f32 v42, v42
    v_exp_f32 v43, v43
    v_smfmac_f32_32x32x32_bf16 v[112:127], v[172:175], v[88:95], v1
    v_exp_f32 v44, v44
    v_exp_f32 v45, v45
    v_exp_f32 v46, v46
    v_exp_f32 v47, v47
    s_waitcnt lgkmcnt(0)
    v_mfma_f32_32x32x16_bf16 v[64:79], v[152:155], v[128:131], 0
    v_exp_f32 v48, v48
    v_exp_f32 v49, v49
    v_exp_f32 v50, v50
    v_exp_f32 v51, v51
    v_mfma_f32_32x32x16_bf16 v[64:79], v[156:159], v[132:135], v[64:79]
    v_exp_f32 v52, v52
    v_exp_f32 v53, v53
    v_exp_f32 v54, v54
    v_exp_f32 v55, v55
    v_smfmac_f32_32x32x32_bf16 v[96:111], v[160:163], v[32:39], v1
    v_exp_f32 v56, v56
    v_exp_f32 v57, v57
    v_exp_f32 v58, v58
    v_exp_f32 v59, v59
    ds_read_b32 v26, v24
    v_smfmac_f32_32x32x32_bf16 v[96:111], v[164:167], v[40:47], v1
    v_exp_f32 v60, v60
    v_exp_f32 v61, v61
    v_exp_f32 v62, v62
    v_exp_f32 v63, v63
L_s4:
    s_waitcnt lgkmcnt(0)
    v_cmp_gt_u32 vcc, 12, v26
    s_cbranch_vccz L_sx4
    ds_read_b32 v26, v24
    s_branch L_s4
L_sx4:
    ds_read_b128 v[144:147], v29 offset:0
    ds_read_b128 v[148:151], v29 offset:1024
    ds_read_b128 v[168:171], v28 offset:47104
    ds_read_b128 v[172:175], v28 offset:48128
    s_setprio 3
    v_mfma_f32_32x32x16_bf16 v[80:95], v[152:155], v[136:139], 0
    v_exp_f32 v64, v64
    v_exp_f32 v65, v65
    v_exp_f32 v66, v66
    v_exp_f32 v67, v67
    v_mfma_f32_32x32x16_bf16 v[80:95], v[156:159], v[140:143], v[80:95]
    v_exp_f32 v68, v68
    v_exp_f32 v69, v69
    v_exp_f32 v70, v70
    v_exp_f32 v71, v71
    s_xor_b32 s50, s41, 5
    s_lshl_b32 s50, s50, 15
    s_add_u32 s50, s50, s49
    s_add_u32 m0, s47, 65536
    s_add_u32 s53, s50, 0
    buffer_load_dwordx4 v5, s[28:31], s53 offen sc1 lds
    v_smfmac_f32_32x32x32_bf16 v[112:127], v[160:163], v[48:55], v1
    v_exp_f32 v72, v72
    v_exp_f32 v73, v73
    v_exp_f32 v74, v74
    v_exp_f32 v75, v75
    v_smfmac_f32_32x32x32_bf16 v[112:127], v[164:167], v[56:63], v1
    v_exp_f32 v76, v76
    v_exp_f32 v77, v77
    v_exp_f32 v78, v78
    v_exp_f32 v79, v79
    s_add_u32 m0, s47, 69632
    s_add_u32 s53, s50, 4096
    buffer_load_dwordx4 v5, s[28:31], s53 offen sc1 lds
    s_waitcnt lgkmcnt(0)
    v_mfma_f32_32x32x16_bf16 v[32:47], v[144:147], v[128:131], 0
    v_exp_f32 v80, v80
    v_exp_f32 v81, v81
    v_exp_f32 v82, v82
    v_exp_f32 v83, v83
    v_mfma_f32_32x32x16_bf16 v[32:47], v[148:151], v[132:135], v[32:47]
    v_exp_f32 v84, v84
    v_exp_f32 v85, v85
    v_exp_f32 v86, v86
    v_exp_f32 v87, v87
    s_add_u32 m0, s47, 73728
    s_add_u32 s53, s50, 8192
    buffer_load_dwordx4 v5, s[28:31], s53 offen sc1 lds
    v_smfmac_f32_32x32x32_bf16 v[96:111], v[168:171], v[64:71], v1
    v_exp_f32 v88, v88
    v_exp_f32 v89, v89
    v_exp_f32 v90, v90
    v_exp_f32 v91, v91
    v_smfmac_f32_32x32x32_bf16 v[96:111], v[172:175], v[72:79], v1
    v_exp_f32 v92, v92
    v_exp_f32 v93, v93
    v_exp_f32 v94, v94
    v_exp_f32 v95, v95
    s_add_u32 m0, s47, 77824
    s_add_u32 s53, s50, 12288
    buffer_load_dwordx4 v5, s[28:31], s53 offen sc1 lds
    ds_read_b128 v[152:155], v29 offset:4096
    ds_read_b128 v[156:159], v29 offset:5120
    ds_read_b128 v[160:163], v29 offset:2048
    ds_read_b128 v[164:167], v29 offset:3072
    s_setprio 2
    v_mfma_f32_32x32x16_bf16 v[48:63], v[144:147], v[136:139], 0
    v_exp_f32 v32, v32
    v_exp_f32 v33, v33
    v_exp_f32 v34, v34
    v_exp_f32 v35, v35
    v_mfma_f32_32x32x16_bf16 v[48:63], v[148:151], v[140:143], v[48:63]
    v_exp_f32 v36, v36
    v_exp_f32 v37, v37
    v_exp_f32 v38, v38
    v_exp_f32 v39, v39
    s_add_u32 m0, s51, 49152
    s_add_u32 s53, s63, 344064
    buffer_load_dwordx4 v30, s[20:23], s53 offen lds
    v_smfmac_f32_32x32x32_bf16 v[112:127], v[168:171], v[80:87], v1
    v_exp_f32 v40, v40
    v_exp_f32 v41, v41
    v_exp_f32 v42, v42
    v_exp_f32 v43, v43
    v_smfmac_f32_32x32x32_bf16 v[112:127], v[172:175], v[88:95], v1
    v_exp_f32 v44, v44
    v_exp_f32 v45, v45
    v_exp_f32 v46, v46
    v_exp_f32 v47, v47
    s_add_u32 s53, s63, 0
    buffer_load_dwordx4 v[180:183], v30, s[24:27], s53 offen
    s_waitcnt lgkmcnt(0)
    v_mfma_f32_32x32x16_bf16 v[64:79], v[152:155], v[128:131], 0
    v_exp_f32 v48, v48
    v_exp_f32 v49, v49
    v_exp_f32 v50, v50
    v_exp_f32 v51, v51
    v_mfma_f32_32x32x16_bf16 v[64:79], v[156:159], v[132:135], v[64:79]
    v_exp_f32 v52, v52
    v_exp_f32 v53, v53
    v_exp_f32 v54, v54
    v_exp_f32 v55, v55
    v_smfmac_f32_32x32x32_bf16 v[96:111], v[160:163], v[32:39], v1
    v_exp_f32 v56, v56
    v_exp_f32 v57, v57
    v_exp_f32 v58, v58
    v_exp_f32 v59, v59
    v_smfmac_f32_32x32x32_bf16 v[96:111], v[164:167], v[40:47], v1
    v_exp_f32 v60, v60
    v_exp_f32 v61, v61
    v_exp_f32 v62, v62
    v_exp_f32 v63, v63
    ds_read_b128 v[144:147], v29 offset:8192
    ds_read_b128 v[148:151], v29 offset:9216
    ds_read_b128 v[168:171], v29 offset:6144
    ds_read_b128 v[172:175], v29 offset:7168
    s_setprio 1
    v_mfma_f32_32x32x16_bf16 v[80:95], v[152:155], v[136:139], 0
    v_exp_f32 v64, v64
    v_exp_f32 v65, v65
    v_exp_f32 v66, v66
    v_exp_f32 v67, v67
    v_mfma_f32_32x32x16_bf16 v[80:95], v[156:159], v[140:143], v[80:95]
    v_exp_f32 v68, v68
    v_exp_f32 v69, v69
    v_exp_f32 v70, v70
    v_exp_f32 v71, v71
    v_smfmac_f32_32x32x32_bf16 v[112:127], v[160:163], v[48:55], v1
    v_exp_f32 v72, v72
    v_exp_f32 v73, v73
    v_exp_f32 v74, v74
    v_exp_f32 v75, v75
    v_smfmac_f32_32x32x32_bf16 v[112:127], v[164:167], v[56:63], v1
    v_exp_f32 v76, v76
    v_exp_f32 v77, v77
    v_exp_f32 v78, v78
    v_exp_f32 v79, v79
    s_waitcnt lgkmcnt(0)
    v_mfma_f32_32x32x16_bf16 v[32:47], v[144:147], v[128:131], 0
    v_exp_f32 v80, v80
    v_exp_f32 v81, v81
    v_exp_f32 v82, v82
    v_exp_f32 v83, v83
    v_mfma_f32_32x32x16_bf16 v[32:47], v[148:151], v[132:135], v[32:47]
    v_exp_f32 v84, v84
    v_exp_f32 v85, v85
    v_exp_f32 v86, v86
    v_exp_f32 v87, v87
    v_smfmac_f32_32x32x32_bf16 v[96:111], v[168:171], v[64:71], v1
    v_exp_f32 v88, v88
    v_exp_f32 v89, v89
    v_exp_f32 v90, v90
    v_exp_f32 v91, v91
    v_smfmac_f32_32x32x32_bf16 v[96:111], v[172:175], v[72:79], v1
    v_exp_f32 v92, v92
    v_exp_f32 v93, v93
    v_exp_f32 v94, v94
    v_exp_f32 v95, v95
    ds_read_b128 v[152:155], v29 offset:12288
    ds_read_b128 v[156:159], v29 offset:13312
    ds_read_b128 v[160:163], v29 offset:10240
    ds_read_b128 v[164:167], v29 offset:11264
    s_setprio 0
    s_waitcnt vmcnt(2)
    s_mov_b64 exec, 1
    ds_add_u32 v24, v25
    s_mov_b64 exec, -1
    v_mfma_f32_32x32x16_bf16 v[48:63], v[144:147], v[136:139], 0
    v_exp_f32 v32, v32
    v_exp_f32 v33, v33
    v_exp_f32 v34, v34
    v_exp_f32 v35, v35
    v_mfma_f32_32x32x16_bf16 v[48:63], v[148:151], v[140:143], v[48:63]
    v_exp_f32 v36, v36
    v_exp_f32 v37, v37
    v_exp_f32 v38, v38
    v_exp_f32 v39, v39
    v_smfmac_f32_32x32x32_bf16 v[112:127], v[168:171], v[80:87], v1
    v_exp_f32 v40, v40
    v_exp_f32 v41, v41
    v_exp_f32 v42, v42
    v_exp_f32 v43, v43
    v_smfmac_f32_32x32x32_bf16 v[112:127], v[172:175], v[88:95], v1
    v_exp_f32 v44, v44
    v_exp_f32 v45, v45
    v_exp_f32 v46, v46
    v_exp_f32 v47, v47
    s_waitcnt lgkmcnt(0)
    v_mfma_f32_32x32x16_bf16 v[64:79], v[152:155], v[128:131], 0
    v_exp_f32 v48, v48
    v_exp_f32 v49, v49
    v_exp_f32 v50, v50
    v_exp_f32 v51, v51
    v_mfma_f32_32x32x16_bf16 v[64:79], v[156:159], v[132:135], v[64:79]
    v_exp_f32 v52, v52
    v_exp_f32 v53, v53
    v_exp_f32 v54, v54
    v_exp_f32 v55, v55
    v_smfmac_f32_32x32x32_bf16 v[96:111], v[160:163], v[32:39], v1
    v_exp_f32 v56, v56
    v_exp_f32 v57, v57
    v_exp_f32 v58, v58
    v_exp_f32 v59, v59
    ds_read_b32 v26, v24
    v_smfmac_f32_32x32x32_bf16 v[96:111], v[164:167], v[40:47], v1
    v_exp_f32 v60, v60
    v_exp_f32 v61, v61
    v_exp_f32 v62, v62
    v_exp_f32 v63, v63
L_s5:
    s_waitcnt lgkmcnt(0)
    v_cmp_gt_u32 vcc, 16, v26
    s_cbranch_vccz L_sx5
    ds_read_b32 v26, v24
    s_branch L_s5
L_sx5:
    ds_read_b128 v[144:147], v28 offset:0
    ds_read_b128 v[148:151], v28 offset:1024
    ds_read_b128 v[168:171], v29 offset:14336
    ds_read_b128 v[172:175], v29 offset:15360
    s_setprio 3
    v_mfma_f32_32x32x16_bf16 v[80:95], v[152:155], v[136:139], 0
    v_exp_f32 v64, v64
    v_exp_f32 v65, v65
    v_exp_f32 v66, v66
    v_exp_f32 v67, v67
    v_mfma_f32_32x32x16_bf16 v[80:95], v[156:159], v[140:143], v[80:95]
    v_exp_f32 v68, v68
    v_exp_f32 v69, v69
    v_exp_f32 v70, v70
    v_exp_f32 v71, v71
    s_xor_b32 s50, s41, 6
    s_lshl_b32 s50, s50, 15
    s_add_u32 s50, s50, s49
    s_add_u32 m0, s47, 98304
    s_add_u32 s53, s50, 0
    buffer_load_dwordx4 v5, s[28:31], s53 offen sc1 lds
    v_smfmac_f32_32x32x32_bf16 v[112:127], v[160:163], v[48:55], v1
    v_exp_f32 v72, v72
    v_exp_f32 v73, v73
    v_exp_f32 v74, v74
    v_exp_f32 v75, v75
    v_smfmac_f32_32x32x32_bf16 v[112:127], v[164:167], v[56:63], v1
    v_exp_f32 v76, v76
    v_exp_f32 v77, v77
    v_exp_f32 v78, v78
    v_exp_f32 v79, v79
    s_add_u32 m0, s47, 102400
    s_add_u32 s53, s50, 4096
    buffer_load_dwordx4 v5, s[28:31], s53 offen sc1 lds
    s_waitcnt lgkmcnt(0)
    v_mfma_f32_32x32x16_bf16 v[32:47], v[144:147], v[128:131], 0
    v_exp_f32 v80, v80
    v_exp_f32 v81, v81
    v_exp_f32 v82, v82
    v_exp_f32 v83, v83
    v_mfma_f32_32x32x16_bf16 v[32:47], v[148:151], v[132:135], v[32:47]
    v_exp_f32 v84, v84
    v_exp_f32 v85, v85
    v_exp_f32 v86, v86
    v_exp_f32 v87, v87
    s_add_u32 m0, s47, 106496
    s_add_u32 s53, s50, 8192
    buffer_load_dwordx4 v5, s[28:31], s53 offen sc1 lds
    v_smfmac_f32_32x32x32_bf16 v[96:111], v[168:171], v[64:71], v1
    v_exp_f32 v88, v88
    v_exp_f32 v89, v89
    v_exp_f32 v90, v90
    v_exp_f32 v91, v91
    v_smfmac_f32_32x32x32_bf16 v[96:111], v[172:175], v[72:79], v1
    v_exp_f32 v92, v92
    v_exp_f32 v93, v93
    v_exp_f32 v94, v94
    v_exp_f32 v95, v95
    s_add_u32 m0, s47, 110592
    s_add_u32 s53, s50, 12288
    buffer_load_dwordx4 v5, s[28:31], s53 offen sc1 lds
    s_lshl_b32 s54, s44, 12
    s_add_u32 s54, s54, 114688
    s_and_b32 s53, s44, 2
    s_mul_i32 s53, s53, 4096
    s_add_u32 s53, s53, s54
    s_add_u32 s53, s53, 16384
    s_cmp_eq_u32 s45, 0
    s_cselect_b32 s52, s54, s53
    s_cselect_b32 s53, s53, s54
    v_add_u32 v6, s52, v5
    v_add_u32 v7, s53, v5
    s_lshl_b32 s52, s41, 3
    s_lshl_b32 s53, s44, 1
    s_add_u32 s52, s52, s53
    s_add_u32 s52, s52, s45
    s_lshl_b32 s52, s52, 5
    s_add_u32 s52, s52, s40
    s_lshl_b32 s55, s52, 11
    s_add_u32 s55, s55, 8388608
    s_and_b32 s52, s2, 7
    s_lshl_b32 s52, s52, 3
    s_lshl_b32 s53, s61, 1
    s_add_u32 s52, s52, s53
    s_and_b32 s53, s42, 1
    s_add_u32 s52, s52, s53
    s_lshl_b32 s59, s52, 2
    s_lshr_b32 s53, s42, 1
    s_add_u32 s59, s59, s53
    s_lshl_b32 s59, s59, 14
    s_add_u32 s59, s59, 8388608
    s_xor_b32 s43, s67, 61321
    s_and_b32 s43, s43, 0xffff
    v_lshlrev_b32 v8, 11, v0
    s_mov_b32 s48, 0xffff
    v_mul_u32_u24 v17, 0x9e37, v0
    v_xor_b32 v17, s67, v17
    v_lshlrev_b32 v17, 16, v17
    s_mov_b32 s56, 0x37800000
    s_mov_b32 s57, 0x5f800000
    s_mov_b32 s58, 0x7e800000
    s_mov_b64 exec, 0xff
    buffer_load_ushort v21, v8, s[28:31], s59 offen offset:2046 sc1
    s_mov_b64 exec, -1
    ds_read_b128 v[152:155], v28 offset:4096
    ds_read_b128 v[156:159], v28 offset:5120
    ds_read_b128 v[160:163], v28 offset:2048
    ds_read_b128 v[164:167], v28 offset:3072
    s_setprio 2
    v_mfma_f32_32x32x16_bf16 v[48:63], v[144:147], v[136:139], 0
    v_exp_f32 v32, v32
    v_exp_f32 v33, v33
    v_exp_f32 v34, v34
    v_exp_f32 v35, v35
    v_mfma_f32_32x32x16_bf16 v[48:63], v[148:151], v[140:143], v[48:63]
    v_exp_f32 v36, v36
    v_exp_f32 v37, v37
    v_exp_f32 v38, v38
    v_exp_f32 v39, v39
    s_add_u32 s53, s63, 57344
    buffer_load_dwordx4 v[180:183], v30, s[24:27], s53 offen
    v_smfmac_f32_32x32x32_bf16 v[112:127], v[168:171], v[80:87], v1
    v_exp_f32 v40, v40
    v_exp_f32 v41, v41
    v_exp_f32 v42, v42
    v_exp_f32 v43, v43
    v_smfmac_f32_32x32x32_bf16 v[112:127], v[172:175], v[88:95], v1
    v_exp_f32 v44, v44
    v_exp_f32 v45, v45
    v_exp_f32 v46, v46
    v_exp_f32 v47, v47
    s_add_u32 s53, s63, 114688
    buffer_load_dwordx4 v[184:187], v30, s[24:27], s53 offen
    s_waitcnt lgkmcnt(0)
    v_mfma_f32_32x32x16_bf16 v[64:79], v[152:155], v[128:131], 0
    v_exp_f32 v48, v48
    v_exp_f32 v49, v49
    v_exp_f32 v50, v50
    v_exp_f32 v51, v51
    v_mfma_f32_32x32x16_bf16 v[64:79], v[156:159], v[132:135], v[64:79]
    v_exp_f32 v52, v52
    v_exp_f32 v53, v53
    v_exp_f32 v54, v54
    v_exp_f32 v55, v55
    s_add_u32 s53, s63, 172032
    buffer_load_dwordx4 v[188:191], v30, s[24:27], s53 offen
    v_smfmac_f32_32x32x32_bf16 v[96:111], v[160:163], v[32:39], v1
    v_exp_f32 v56, v56
    v_exp_f32 v57, v57
    v_exp_f32 v58, v58
    v_exp_f32 v59, v59
    v_smfmac_f32_32x32x32_bf16 v[96:111], v[164:167], v[40:47], v1
    v_exp_f32 v60, v60
    v_exp_f32 v61, v61
    v_exp_f32 v62, v62
    v_exp_f32 v63, v63
    ds_read_b128 v[144:147], v28 offset:8192
    ds_read_b128 v[148:151], v28 offset:9216
    ds_read_b128 v[168:171], v28 offset:6144
    ds_read_b128 v[172:175], v28 offset:7168
    s_setprio 1
    v_mfma_f32_32x32x16_bf16 v[80:95], v[152:155], v[136:139], 0
    v_exp_f32 v64, v64
    v_exp_f32 v65, v65
    v_exp_f32 v66, v66
    v_exp_f32 v67, v67
    v_mfma_f32_32x32x16_bf16 v[80:95], v[156:159], v[140:143], v[80:95]
    v_exp_f32 v68, v68
    v_exp_f32 v69, v69
    v_exp_f32 v70, v70
    v_exp_f32 v71, v71
    v_smfmac_f32_32x32x32_bf16 v[112:127], v[160:163], v[48:55], v1
    v_exp_f32 v72, v72
    v_exp_f32 v73, v73
    v_exp_f32 v74, v74
    v_exp_f32 v75, v75
    v_smfmac_f32_32x32x32_bf16 v[112:127], v[164:167], v[56:63], v1
    v_exp_f32 v76, v76
    v_exp_f32 v77, v77
    v_exp_f32 v78, v78
    v_exp_f32 v79, v79
    s_waitcnt lgkmcnt(0)
    v_mfma_f32_32x32x16_bf16 v[32:47], v[144:147], v[128:131], 0
    v_exp_f32 v80, v80
    v_exp_f32 v81, v81
    v_exp_f32 v82, v82
    v_exp_f32 v83, v83
    v_mfma_f32_32x32x16_bf16 v[32:47], v[148:151], v[132:135], v[32:47]
    v_exp_f32 v84, v84
    v_exp_f32 v85, v85
    v_exp_f32 v86, v86
    v_exp_f32 v87, v87
    v_smfmac_f32_32x32x32_bf16 v[96:111], v[168:171], v[64:71], v1
    v_exp_f32 v88, v88
    v_exp_f32 v89, v89
    v_exp_f32 v90, v90
    v_exp_f32 v91, v91
    v_smfmac_f32_32x32x32_bf16 v[96:111], v[172:175], v[72:79], v1
    v_exp_f32 v92, v92
    v_exp_f32 v93, v93
    v_exp_f32 v94, v94
    v_exp_f32 v95, v95
    ds_read_b128 v[152:155], v28 offset:12288
    ds_read_b128 v[156:159], v28 offset:13312
    ds_read_b128 v[160:163], v28 offset:10240
    ds_read_b128 v[164:167], v28 offset:11264
    s_setprio 0
    s_waitcnt vmcnt(4)
    s_mov_b64 exec, 1
    ds_add_u32 v24, v25
    s_mov_b64 exec, -1
    v_mfma_f32_32x32x16_bf16 v[48:63], v[144:147], v[136:139], 0
    v_exp_f32 v32, v32
    v_exp_f32 v33, v33
    v_exp_f32 v34, v34
    v_exp_f32 v35, v35
    v_mfma_f32_32x32x16_bf16 v[48:63], v[148:151], v[140:143], v[48:63]
    v_exp_f32 v36, v36
    v_exp_f32 v37, v37
    v_exp_f32 v38, v38
    v_exp_f32 v39, v39
    v_smfmac_f32_32x32x32_bf16 v[112:127], v[168:171], v[80:87], v1
    v_exp_f32 v40, v40
    v_exp_f32 v41, v41
    v_exp_f32 v42, v42
    v_exp_f32 v43, v43
    v_smfmac_f32_32x32x32_bf16 v[112:127], v[172:175], v[88:95], v1
    v_exp_f32 v44, v44
    v_exp_f32 v45, v45
    v_exp_f32 v46, v46
    v_exp_f32 v47, v47
    s_waitcnt lgkmcnt(0)
    v_mfma_f32_32x32x16_bf16 v[64:79], v[152:155], v[128:131], 0
    v_exp_f32 v48, v48
    v_exp_f32 v49, v49
    v_exp_f32 v50, v50
    v_exp_f32 v51, v51
    v_mfma_f32_32x32x16_bf16 v[64:79], v[156:159], v[132:135], v[64:79]
    v_exp_f32 v52, v52
    v_exp_f32 v53, v53
    v_exp_f32 v54, v54
    v_exp_f32 v55, v55
    v_smfmac_f32_32x32x32_bf16 v[96:111], v[160:163], v[32:39], v1
    v_exp_f32 v56, v56
    v_exp_f32 v57, v57
    v_exp_f32 v58, v58
    v_exp_f32 v59, v59
    ds_read_b32 v26, v24
    v_smfmac_f32_32x32x32_bf16 v[96:111], v[164:167], v[40:47], v1
    v_exp_f32 v60, v60
    v_exp_f32 v61, v61
    v_exp_f32 v62, v62
    v_exp_f32 v63, v63
L_s6:
    s_waitcnt lgkmcnt(0)
    v_cmp_gt_u32 vcc, 20, v26
    s_cbranch_vccz L_sx6
    ds_read_b32 v26, v24
    s_branch L_s6
L_sx6:
    ds_read_b128 v[144:147], v28 offset:32768
    ds_read_b128 v[148:151], v28 offset:33792
    ds_read_b128 v[168:171], v28 offset:14336
    ds_read_b128 v[172:175], v28 offset:15360
    s_setprio 3
    v_mfma_f32_32x32x16_bf16 v[80:95], v[152:155], v[136:139], 0
    v_exp_f32 v64, v64
    v_exp_f32 v65, v65
    v_exp_f32 v66, v66
    v_exp_f32 v67, v67
    v_mfma_f32_32x32x16_bf16 v[80:95], v[156:159], v[140:143], v[80:95]
    v_exp_f32 v68, v68
    v_exp_f32 v69, v69
    v_exp_f32 v70, v70
    v_exp_f32 v71, v71
    s_xor_b32 s50, s41, 7
    s_lshl_b32 s50, s50, 15
    s_add_u32 s50, s50, s49
    s_add_u32 m0, s47, 131072
    s_add_u32 s53, s50, 0
    buffer_load_dwordx4 v5, s[28:31], s53 offen sc1 lds
    v_smfmac_f32_32x32x32_bf16 v[112:127], v[160:163], v[48:55], v1
    v_exp_f32 v72, v72
    v_exp_f32 v73, v73
    v_exp_f32 v74, v74
    v_exp_f32 v75, v75
    v_smfmac_f32_32x32x32_bf16 v[112:127], v[164:167], v[56:63], v1
    v_exp_f32 v76, v76
    v_exp_f32 v77, v77
    v_exp_f32 v78, v78
    v_exp_f32 v79, v79
    s_add_u32 m0, s47, 135168
    s_add_u32 s53, s50, 4096
    buffer_load_dwordx4 v5, s[28:31], s53 offen sc1 lds
    s_waitcnt lgkmcnt(0)
    v_mfma_f32_32x32x16_bf16 v[32:47], v[144:147], v[128:131], 0
    v_exp_f32 v80, v80
    v_exp_f32 v81, v81
    v_exp_f32 v82, v82
    v_exp_f32 v83, v83
    v_mfma_f32_32x32x16_bf16 v[32:47], v[148:151], v[132:135], v[32:47]
    v_exp_f32 v84, v84
    v_exp_f32 v85, v85
    v_exp_f32 v86, v86
    v_exp_f32 v87, v87
    s_add_u32 m0, s47, 139264
    s_add_u32 s53, s50, 8192
    buffer_load_dwordx4 v5, s[28:31], s53 offen sc1 lds
    v_smfmac_f32_32x32x32_bf16 v[96:111], v[168:171], v[64:71], v1
    v_exp_f32 v88, v88
    v_exp_f32 v89, v89
    v_exp_f32 v90, v90
    v_exp_f32 v91, v91
    v_smfmac_f32_32x32x32_bf16 v[96:111], v[172:175], v[72:79], v1
    v_exp_f32 v92, v92
    v_exp_f32 v93, v93
    v_exp_f32 v94, v94
    v_exp_f32 v95, v95
    s_add_u32 m0, s47, 143360
    s_add_u32 s53, s50, 12288
    buffer_load_dwordx4 v5, s[28:31], s53 offen sc1 lds
    ds_read_b128 v[152:155], v28 offset:36864
    ds_read_b128 v[156:159], v28 offset:37888
    ds_read_b128 v[160:163], v28 offset:34816
    ds_read_b128 v[164:167], v28 offset:35840
    s_setprio 2
    v_mfma_f32_32x32x16_bf16 v[48:63], v[144:147], v[136:139], 0
    v_exp_f32 v32, v32
    v_exp_f32 v33, v33
    v_exp_f32 v34, v34
    v_exp_f32 v35, v35
    v_mfma_f32_32x32x16_bf16 v[48:63], v[148:151], v[140:143], v[48:63]
    v_exp_f32 v36, v36
    v_exp_f32 v37, v37
    v_exp_f32 v38, v38
    v_exp_f32 v39, v39
    s_add_u32 s53, s63, 229376
    buffer_load_dwordx4 v[180:183], v30, s[24:27], s53 offen
    v_smfmac_f32_32x32x32_bf16 v[112:127], v[168:171], v[80:87], v1
    v_exp_f32 v40, v40
    v_exp_f32 v41, v41
    v_exp_f32 v42, v42
    v_exp_f32 v43, v43
    v_smfmac_f32_32x32x32_bf16 v[112:127], v[172:175], v[88:95], v1
    v_exp_f32 v44, v44
    v_exp_f32 v45, v45
    v_exp_f32 v46, v46
    v_exp_f32 v47, v47
    s_add_u32 s53, s63, 286720
    buffer_load_dwordx4 v[184:187], v30, s[24:27], s53 offen
    s_waitcnt lgkmcnt(0)
    v_mfma_f32_32x32x16_bf16 v[64:79], v[152:155], v[128:131], 0
    v_exp_f32 v48, v48
    v_exp_f32 v49, v49
    v_exp_f32 v50, v50
    v_exp_f32 v51, v51
    v_mfma_f32_32x32x16_bf16 v[64:79], v[156:159], v[132:135], v[64:79]
    v_exp_f32 v52, v52
    v_exp_f32 v53, v53
    v_exp_f32 v54, v54
    v_exp_f32 v55, v55
    s_add_u32 s53, s63, 344064
    buffer_load_dwordx4 v[188:191], v30, s[24:27], s53 offen
    v_smfmac_f32_32x32x32_bf16 v[96:111], v[160:163], v[32:39], v1
    v_exp_f32 v56, v56
    v_exp_f32 v57, v57
    v_exp_f32 v58, v58
    v_exp_f32 v59, v59
    v_smfmac_f32_32x32x32_bf16 v[96:111], v[164:167], v[40:47], v1
    v_exp_f32 v60, v60
    v_exp_f32 v61, v61
    v_exp_f32 v62, v62
    v_exp_f32 v63, v63
    ds_read_b128 v[144:147], v28 offset:40960
    ds_read_b128 v[148:151], v28 offset:41984
    ds_read_b128 v[168:171], v28 offset:38912
    ds_read_b128 v[172:175], v28 offset:39936
    s_setprio 1
    v_mfma_f32_32x32x16_bf16 v[80:95], v[152:155], v[136:139], 0
    v_exp_f32 v64, v64
    v_exp_f32 v65, v65
    v_exp_f32 v66, v66
    v_exp_f32 v67, v67
    v_mfma_f32_32x32x16_bf16 v[80:95], v[156:159], v[140:143], v[80:95]
    v_exp_f32 v68, v68
    v_exp_f32 v69, v69
    v_exp_f32 v70, v70
    v_exp_f32 v71, v71
    v_smfmac_f32_32x32x32_bf16 v[112:127], v[160:163], v[48:55], v1
    v_exp_f32 v72, v72
    v_exp_f32 v73, v73
    v_exp_f32 v74, v74
    v_exp_f32 v75, v75
    v_smfmac_f32_32x32x32_bf16 v[112:127], v[164:167], v[56:63], v1
    v_exp_f32 v76, v76
    v_exp_f32 v77, v77
    v_exp_f32 v78, v78
    v_exp_f32 v79, v79
    s_waitcnt lgkmcnt(0)
    v_mfma_f32_32x32x16_bf16 v[32:47], v[144:147], v[128:131], 0
    v_exp_f32 v80, v80
    v_exp_f32 v81, v81
    v_exp_f32 v82, v82
    v_exp_f32 v83, v83
    v_mfma_f32_32x32x16_bf16 v[32:47], v[148:151], v[132:135], v[32:47]
    v_exp_f32 v84, v84
    v_exp_f32 v85, v85
    v_exp_f32 v86, v86
    v_exp_f32 v87, v87
    v_smfmac_f32_32x32x32_bf16 v[96:111], v[168:171], v[64:71], v1
    v_exp_f32 v88, v88
    v_exp_f32 v89, v89
    v_exp_f32 v90, v90
    v_exp_f32 v91, v91
    v_smfmac_f32_32x32x32_bf16 v[96:111], v[172:175], v[72:79], v1
    v_exp_f32 v92, v92
    v_exp_f32 v93, v93
    v_exp_f32 v94, v94
    v_exp_f32 v95, v95
    ds_read_b128 v[152:155], v28 offset:45056
    ds_read_b128 v[156:159], v28 offset:46080
    ds_read_b128 v[160:163], v28 offset:43008
    ds_read_b128 v[164:167], v28 offset:44032
    s_setprio 0
    s_waitcnt vmcnt(3)
    s_mov_b64 exec, 1
    ds_add_u32 v24, v25
    s_mov_b64 exec, -1
    v_mfma_f32_32x32x16_bf16 v[48:63], v[144:147], v[136:139], 0
    v_exp_f32 v32, v32
    v_exp_f32 v33, v33
    v_exp_f32 v34, v34
    v_exp_f32 v35, v35
    v_mfma_f32_32x32x16_bf16 v[48:63], v[148:151], v[140:143], v[48:63]
    v_exp_f32 v36, v36
    v_exp_f32 v37, v37
    v_exp_f32 v38, v38
    v_exp_f32 v39, v39
    v_smfmac_f32_32x32x32_bf16 v[112:127], v[168:171], v[80:87], v1
    v_exp_f32 v40, v40
    v_exp_f32 v41, v41
    v_exp_f32 v42, v42
    v_exp_f32 v43, v43
    v_smfmac_f32_32x32x32_bf16 v[112:127], v[172:175], v[88:95], v1
    v_exp_f32 v44, v44
    v_exp_f32 v45, v45
    v_exp_f32 v46, v46
    v_exp_f32 v47, v47
    s_waitcnt lgkmcnt(0)
    v_mfma_f32_32x32x16_bf16 v[64:79], v[152:155], v[128:131], 0
    v_exp_f32 v48, v48
    v_exp_f32 v49, v49
    v_exp_f32 v50, v50
    v_exp_f32 v51, v51
    v_mfma_f32_32x32x16_bf16 v[64:79], v[156:159], v[132:135], v[64:79]
    v_exp_f32 v52, v52
    v_exp_f32 v53, v53
    v_exp_f32 v54, v54
    v_exp_f32 v55, v55
    v_smfmac_f32_32x32x32_bf16 v[96:111], v[160:163], v[32:39], v1
    v_exp_f32 v56, v56
    v_exp_f32 v57, v57
    v_exp_f32 v58, v58
    v_exp_f32 v59, v59
    ds_read_b64 v[26:27], v31 offset:57344
    v_smfmac_f32_32x32x32_bf16 v[96:111], v[164:167], v[40:47], v1
    v_exp_f32 v60, v60
    v_exp_f32 v61, v61
    v_exp_f32 v62, v62
    v_exp_f32 v63, v63
L_s7:
    s_waitcnt lgkmcnt(0)
    v_min_u32 v26, v26, v27
    v_cmp_gt_u32 vcc, 24, v26
    s_cbranch_vccz L_sx7
    ds_read_b64 v[26:27], v31 offset:57344
    s_branch L_s7
L_sx7:
    ds_read_b128 v[144:147], v29 offset:0
    ds_read_b128 v[148:151], v29 offset:1024
    ds_read_b128 v[168:171], v28 offset:47104
    ds_read_b128 v[172:175], v28 offset:48128
    s_setprio 3
    v_mfma_f32_32x32x16_bf16 v[80:95], v[152:155], v[136:139], 0
    v_exp_f32 v64, v64
    v_exp_f32 v65, v65
    v_exp_f32 v66, v66
    v_exp_f32 v67, v67
    v_mfma_f32_32x32x16_bf16 v[80:95], v[156:159], v[140:143], v[80:95]
    v_exp_f32 v68, v68
    v_exp_f32 v69, v69
    v_exp_f32 v70, v70
    v_exp_f32 v71, v71
    s_add_u32 m0, s51, 65536
    s_add_u32 s53, s63, 57344
    buffer_load_dwordx4 v30, s[24:27], s53 offen lds
    v_smfmac_f32_32x32x32_bf16 v[112:127], v[160:163], v[48:55], v1
    v_exp_f32 v72, v72
    v_exp_f32 v73, v73
    v_exp_f32 v74, v74
    v_exp_f32 v75, v75
    v_smfmac_f32_32x32x32_bf16 v[112:127], v[164:167], v[56:63], v1
    v_exp_f32 v76, v76
    v_exp_f32 v77, v77
    v_exp_f32 v78, v78
    v_exp_f32 v79, v79
    s_add_u32 m0, s51, 73728
    s_add_u32 s53, s63, 114688
    buffer_load_dwordx4 v30, s[24:27], s53 offen lds
    s_waitcnt lgkmcnt(0)
    v_mfma_f32_32x32x16_bf16 v[32:47], v[144:147], v[128:131], 0
    v_exp_f32 v80, v80
    v_exp_f32 v81, v81
    v_exp_f32 v82, v82
    v_exp_f32 v83, v83
    v_mfma_f32_32x32x16_bf16 v[32:47], v[148:151], v[132:135], v[32:47]
    v_exp_f32 v84, v84
    v_exp_f32 v85, v85
    v_exp_f32 v86, v86
    v_exp_f32 v87, v87
    s_add_u32 m0, s51, 81920
    s_add_u32 s53, s63, 172032
    buffer_load_dwordx4 v30, s[24:27], s53 offen lds
    v_smfmac_f32_32x32x32_bf16 v[96:111], v[168:171], v[64:71], v1
    v_exp_f32 v88, v88
    v_exp_f32 v89, v89
    v_exp_f32 v90, v90
    v_exp_f32 v91, v91
    v_smfmac_f32_32x32x32_bf16 v[96:111], v[172:175], v[72:79], v1
    v_exp_f32 v92, v92
    v_exp_f32 v93, v93
    v_exp_f32 v94, v94
    v_exp_f32 v95, v95
    s_add_u32 m0, s51, 90112
    s_add_u32 s53, s63, 229376
    buffer_load_dwordx4 v30, s[24:27], s53 offen lds
    ds_read_b128 v[152:155], v29 offset:4096
    ds_read_b128 v[156:159], v29 offset:5120
    ds_read_b128 v[160:163], v29 offset:2048
    ds_read_b128 v[164:167], v29 offset:3072
    s_setprio 2
    v_mfma_f32_32x32x16_bf16 v[48:63], v[144:147], v[136:139], 0
    v_exp_f32 v32, v32
    v_exp_f32 v33, v33
    v_exp_f32 v34, v34
    v_exp_f32 v35, v35
    v_mfma_f32_32x32x16_bf16 v[48:63], v[148:151], v[140:143], v[48:63]
    v_exp_f32 v36, v36
    v_exp_f32 v37, v37
    v_exp_f32 v38, v38
    v_exp_f32 v39, v39
    v_smfmac_f32_32x32x32_bf16 v[112:127], v[168:171], v[80:87], v1
    v_exp_f32 v40, v40
    v_exp_f32 v41, v41
    v_exp_f32 v42, v42
    v_exp_f32 v43, v43
    v_smfmac_f32_32x32x32_bf16 v[112:127], v[172:175], v[88:95], v1
    v_exp_f32 v44, v44
    v_exp_f32 v45, v45
    v_exp_f32 v46, v46
    v_exp_f32 v47, v47
    s_waitcnt lgkmcnt(0)
    v_mfma_f32_32x32x16_bf16 v[64:79], v[152:155], v[128:131], 0
    v_exp_f32 v48, v48
    v_exp_f32 v49, v49
    v_exp_f32 v50, v50
    v_exp_f32 v51, v51
    v_mfma_f32_32x32x16_bf16 v[64:79], v[156:159], v[132:135], v[64:79]
    v_exp_f32 v52, v52
    v_exp_f32 v53, v53
    v_exp_f32 v54, v54
    v_exp_f32 v55, v55
    v_smfmac_f32_32x32x32_bf16 v[96:111], v[160:163], v[32:39], v1
    v_exp_f32 v56, v56
    v_exp_f32 v57, v57
    v_exp_f32 v58, v58
    v_exp_f32 v59, v59
    v_smfmac_f32_32x32x32_bf16 v[96:111], v[164:167], v[40:47], v1
    v_exp_f32 v60, v60
    v_exp_f32 v61, v61
    v_exp_f32 v62, v62
    v_exp_f32 v63, v63
    ds_read_b128 v[144:147], v29 offset:8192
    ds_read_b128 v[148:151], v29 offset:9216
    ds_read_b128 v[168:171], v29 offset:6144
    ds_read_b128 v[172:175], v29 offset:7168
    s_setprio 1
    v_mfma_f32_32x32x16_bf16 v[80:95], v[152:155], v[136:139], 0
    v_exp_f32 v64, v64
    v_exp_f32 v65, v65
    v_exp_f32 v66, v66
    v_exp_f32 v67, v67
    v_mfma_f32_32x32x16_bf16 v[80:95], v[156:159], v[140:143], v[80:95]
    v_exp_f32 v68, v68
    v_exp_f32 v69, v69
    v_exp_f32 v70, v70
    v_exp_f32 v71, v71
    v_smfmac_f32_32x32x32_bf16 v[112:127], v[160:163], v[48:55], v1
    v_exp_f32 v72, v72
    v_exp_f32 v73, v73
    v_exp_f32 v74, v74
    v_exp_f32 v75, v75
    v_smfmac_f32_32x32x32_bf16 v[112:127], v[164:167], v[56:63], v1
    v_exp_f32 v76, v76
    v_exp_f32 v77, v77
    v_exp_f32 v78, v78
    v_exp_f32 v79, v79
    s_waitcnt lgkmcnt(0)
    v_mfma_f32_32x32x16_bf16 v[32:47], v[144:147], v[128:131], 0
    v_exp_f32 v80, v80
    v_exp_f32 v81, v81
    v_exp_f32 v82, v82
    v_exp_f32 v83, v83
    v_mfma_f32_32x32x16_bf16 v[32:47], v[148:151], v[132:135], v[32:47]
    v_exp_f32 v84, v84
    v_exp_f32 v85, v85
    v_exp_f32 v86, v86
    v_exp_f32 v87, v87
    v_smfmac_f32_32x32x32_bf16 v[96:111], v[168:171], v[64:71], v1
    v_exp_f32 v88, v88
    v_exp_f32 v89, v89
    v_exp_f32 v90, v90
    v_exp_f32 v91, v91
    v_smfmac_f32_32x32x32_bf16 v[96:111], v[172:175], v[72:79], v1
    v_exp_f32 v92, v92
    v_exp_f32 v93, v93
    v_exp_f32 v94, v94
    v_exp_f32 v95, v95
    ds_read_b128 v[152:155], v29 offset:12288
    ds_read_b128 v[156:159], v29 offset:13312
    ds_read_b128 v[160:163], v29 offset:10240
    ds_read_b128 v[164:167], v29 offset:11264
    s_setprio 0
    v_mfma_f32_32x32x16_bf16 v[48:63], v[144:147], v[136:139], 0
    v_exp_f32 v32, v32
    v_exp_f32 v33, v33
    v_exp_f32 v34, v34
    v_exp_f32 v35, v35
    v_mfma_f32_32x32x16_bf16 v[48:63], v[148:151], v[140:143], v[48:63]
    v_exp_f32 v36, v36
    v_exp_f32 v37, v37
    v_exp_f32 v38, v38
    v_exp_f32 v39, v39
    v_smfmac_f32_32x32x32_bf16 v[112:127], v[168:171], v[80:87], v1
    v_exp_f32 v40, v40
    v_exp_f32 v41, v41
    v_exp_f32 v42, v42
    v_exp_f32 v43, v43
    v_smfmac_f32_32x32x32_bf16 v[112:127], v[172:175], v[88:95], v1
    v_exp_f32 v44, v44
    v_exp_f32 v45, v45
    v_exp_f32 v46, v46
    v_exp_f32 v47, v47
    s_waitcnt lgkmcnt(0)
    v_mfma_f32_32x32x16_bf16 v[64:79], v[152:155], v[128:131], 0
    v_exp_f32 v48, v48
    v_exp_f32 v49, v49
    v_exp_f32 v50, v50
    v_exp_f32 v51, v51
    v_mfma_f32_32x32x16_bf16 v[64:79], v[156:159], v[132:135], v[64:79]
    v_exp_f32 v52, v52
    v_exp_f32 v53, v53
    v_exp_f32 v54, v54
    v_exp_f32 v55, v55
    v_smfmac_f32_32x32x32_bf16 v[96:111], v[160:163], v[32:39], v1
    v_exp_f32 v56, v56
    v_exp_f32 v57, v57
    v_exp_f32 v58, v58
    v_exp_f32 v59, v59
    v_smfmac_f32_32x32x32_bf16 v[96:111], v[164:167], v[40:47], v1
    v_exp_f32 v60, v60
    v_exp_f32 v61, v61
    v_exp_f32 v62, v62
    v_exp_f32 v63, v63
    s_barrier
    ds_read_b128 v[168:171], v29 offset:14336
    ds_read_b128 v[172:175], v29 offset:15360
    s_setprio 3
    v_mfma_f32_32x32x16_bf16 v[80:95], v[152:155], v[136:139], 0
    v_exp_f32 v64, v64
    v_exp_f32 v65, v65
    v_exp_f32 v66, v66
    v_exp_f32 v67, v67
    v_mfma_f32_32x32x16_bf16 v[80:95], v[156:159], v[140:143], v[80:95]
    v_exp_f32 v68, v68
    v_exp_f32 v69, v69
    v_exp_f32 v70, v70
    v_exp_f32 v71, v71
    s_add_u32 m0, s51, 57344
    s_add_u32 s53, s63, 0
    buffer_load_dwordx4 v30, s[24:27], s53 offen lds
    v_smfmac_f32_32x32x32_bf16 v[112:127], v[160:163], v[48:55], v1
    v_exp_f32 v72, v72
    v_exp_f32 v73, v73
    v_exp_f32 v74, v74
    v_exp_f32 v75, v75
    v_smfmac_f32_32x32x32_bf16 v[112:127], v[164:167], v[56:63], v1
    v_exp_f32 v76, v76
    v_exp_f32 v77, v77
    v_exp_f32 v78, v78
    v_exp_f32 v79, v79
    s_add_u32 m0, s51, 98304
    s_add_u32 s53, s63, 286720
    buffer_load_dwordx4 v30, s[24:27], s53 offen lds
    s_waitcnt lgkmcnt(0)
    v_smfmac_f32_32x32x32_bf16 v[96:111], v[168:171], v[64:71], v1
    v_exp_f32 v80, v80
    v_exp_f32 v81, v81
    v_exp_f32 v82, v82
    v_exp_f32 v83, v83
    v_smfmac_f32_32x32x32_bf16 v[96:111], v[172:175], v[72:79], v1
    v_exp_f32 v84, v84
    v_exp_f32 v85, v85
    v_exp_f32 v86, v86
    v_exp_f32 v87, v87
    s_add_u32 m0, s51, 106496
    s_add_u32 s53, s63, 344064
    buffer_load_dwordx4 v30, s[24:27], s53 offen lds
    v_exp_f32 v88, v88
    v_exp_f32 v89, v89
    v_exp_f32 v90, v90
    v_exp_f32 v91, v91
    v_exp_f32 v92, v92
    v_exp_f32 v93, v93
    v_exp_f32 v94, v94
    v_exp_f32 v95, v95
    ds_write_b128 v6, v[96:99]
    ds_write_b128 v6, v[100:103] offset:1024
    v_smfmac_f32_32x32x32_bf16 v[112:127], v[168:171], v[80:87], v1
    ds_write_b128 v6, v[104:107] offset:2048
    ds_write_b128 v6, v[108:111] offset:3072
    v_smfmac_f32_32x32x32_bf16 v[112:127], v[172:175], v[88:95], v1
    s_setprio 0
    s_mov_b64 exec, 0xff
    buffer_load_ushort v21, v8, s[28:31], s59 offen offset:2046 sc1
    s_mov_b64 exec, -1
    s_waitcnt lgkmcnt(0)
    s_barrier
    ds_read_b128 v[48:51], v7 offset:0
    ds_read_b128 v[52:55], v7 offset:1024
    ds_read_b128 v[56:59], v7 offset:2048
    ds_read_b128 v[60:63], v7 offset:3072
    s_nop 1
    s_waitcnt lgkmcnt(3)
    v_pk_add_f32 v[32:33], v[112:113], v[48:49]
    v_pk_add_f32 v[34:35], v[114:115], v[50:51]
    s_waitcnt lgkmcnt(2)
    v_pk_add_f32 v[36:37], v[116:117], v[52:53]
    v_pk_add_f32 v[38:39], v[118:119], v[54:55]
    s_waitcnt lgkmcnt(1)
    v_pk_add_f32 v[40:41], v[120:121], v[56:57]
    v_pk_add_f32 v[42:43], v[122:123], v[58:59]
    s_waitcnt lgkmcnt(0)
    v_pk_add_f32 v[44:45], v[124:125], v[60:61]
    v_pk_add_f32 v[46:47], v[126:127], v[62:63]
    v_add_f32 v11, abs(v32), abs(v33)
    v_add_f32 v12, abs(v34), abs(v35)
    v_add_f32 v11, abs(v36), v11
    v_add_f32 v12, abs(v37), v12
    v_add_f32 v11, abs(v38), v11
    v_add_f32 v12, abs(v39), v12
    v_add_f32 v11, abs(v40), v11
    v_add_f32 v12, abs(v41), v12
    v_add_f32 v11, abs(v42), v11
    v_add_f32 v12, abs(v43), v12
    v_add_f32 v11, abs(v44), v11
    v_add_f32 v12, abs(v45), v12
    v_add_f32 v11, abs(v46), v11
    v_add_f32 v12, abs(v47), v12
    v_cmp_le_f32 s[64:65], s56, v39
    v_add_f32 v11, v11, v12
    v_cmp_ge_f32 vcc, s57, v39
    s_and_b64 s[64:65], s[64:65], vcc
    v_cmp_ge_f32 vcc, s58, v11
    s_and_b64 s[64:65], s[64:65], vcc
    s_cmp_eq_u64 s[64:65], exec
    s_cbranch_scc0 L_fallback
L_fin:
    v_rcp_f32 v10, v39
    s_nop 0
    v_pk_mul_f32 v[32:33], v[32:33], v[10:11] op_sel_hi:[1,0]
    v_pk_mul_f32 v[34:35], v[34:35], v[10:11] op_sel_hi:[1,0]
    v_pk_mul_f32 v[36:37], v[36:37], v[10:11] op_sel_hi:[1,0]
    v_pk_mul_f32 v[38:39], v[38:39], v[10:11] op_sel_hi:[1,0]
    v_cvt_pk_bf16_f32 v123, v38, v39
    v_cvt_pk_bf16_f32 v120, v32, v33
    v_cvt_pk_bf16_f32 v121, v34, v35
    v_cvt_pk_bf16_f32 v122, v36, v37
    v_and_or_b32 v123, v123, s48, v17
    buffer_store_dwordx4 v[120:123], v5, s[28:31], s55 offen offset:0 sc1
    v_pk_mul_f32 v[40:41], v[40:41], v[10:11] op_sel_hi:[1,0]
    v_pk_mul_f32 v[42:43], v[42:43], v[10:11] op_sel_hi:[1,0]
    v_pk_mul_f32 v[44:45], v[44:45], v[10:11] op_sel_hi:[1,0]
    v_pk_mul_f32 v[46:47], v[46:47], v[10:11] op_sel_hi:[1,0]
    v_cvt_pk_bf16_f32 v127, v46, v47
    v_cvt_pk_bf16_f32 v124, v40, v41
    v_cvt_pk_bf16_f32 v125, v42, v43
    v_cvt_pk_bf16_f32 v126, v44, v45
    v_and_or_b32 v127, v127, s48, v17
    buffer_store_dwordx4 v[124:127], v5, s[28:31], s55 offen offset:1024 sc1
    s_cmp_ge_u32 s2, 224
    s_cbranch_scc1 L_end
    s_waitcnt vmcnt(2)
    v_cmp_eq_u32 vcc, s43, v21
    s_mov_b32 s49, 0xff
    s_mov_b32 s60, 131072
    s_and_b32 s50, vcc_lo, s49
    s_xor_b32 s54, s50, s49
    s_lshl_b32 s54, s54, 8
    s_or_b32 s54, s54, s50
    s_bcnt1_i32_b32 s51, s50
    s_cmp_ge_u32 s51, 4
    s_cselect_b32 s51, 8, s51
    s_cselect_b32 s50, s49, s50
    s_ff1_i32_b32 s53, s54
    s_bitset0_b32 s54, s53
    s_and_b32 s4, s53, 7
    s_ff1_i32_b32 s53, s54
    s_bitset0_b32 s54, s53
    s_and_b32 s5, s53, 7
    s_ff1_i32_b32 s53, s54
    s_bitset0_b32 s54, s53
    s_and_b32 s6, s53, 7
    s_ff1_i32_b32 s53, s54
    s_bitset0_b32 s54, s53
    s_and_b32 s7, s53, 7
    s_ff1_i32_b32 s53, s54
    s_bitset0_b32 s54, s53
    s_and_b32 s8, s53, 7
    s_ff1_i32_b32 s53, s54
    s_bitset0_b32 s54, s53
    s_and_b32 s9, s53, 7
    s_ff1_i32_b32 s53, s54
    s_bitset0_b32 s54, s53
    s_and_b32 s10, s53, 7
    s_ff1_i32_b32 s53, s54
    s_bitset0_b32 s54, s53
    s_and_b32 s11, s53, 7
    v_and_b32 v6, 31, v0
    v_lshlrev_b32 v7, 3, v6
    s_lshl_b32 s47, s52, 8
    s_add_u32 s47, s47, 12910592
    s_barrier
    buffer_load_dwordx2 v[22:23], v7, s[28:31], s47 offen sc1
    s_cmp_le_u32 s51, 0
    s_cbranch_scc1 L_first
    s_lshl_b32 s53, s4, 11
    s_add_u32 s53, s53, s59
    buffer_load_dwordx4 v[64:67], v5, s[28:31], s53 offen offset:0 sc1
    buffer_load_dwordx4 v[68:71], v5, s[28:31], s53 offen offset:1024 sc1
    s_cmp_le_u32 s51, 1
    s_cbranch_scc1 L_first
    s_lshl_b32 s53, s5, 11
    s_add_u32 s53, s53, s59
    buffer_load_dwordx4 v[72:75], v5, s[28:31], s53 offen offset:0 sc1
    buffer_load_dwordx4 v[76:79], v5, s[28:31], s53 offen offset:1024 sc1
L_first:
    s_mov_b32 s32, s18
    s_mov_b32 s33, s19
    s_mov_b32 s34, 1835008
    s_mov_b32 s35, 0x00020000
    s_and_b32 s44, s42, 1
    s_lshr_b32 s45, s42, 1
    s_mov_b32 s46, s52
    v_lshrrev_b32 v18, 5, v0
    v_lshrrev_b32 v14, 2, v0
    v_and_b32 v14, 3, v14
    v_lshl_add_u32 v10, v18, 2, v14
    v_min_u32 v14, 2, v14
    v_mad_u32_u24 v12, v18, 3, v14
    v_lshrrev_b32 v14, 4, v0
    v_and_b32 v14, 1, v14
    v_and_b32 v11, 3, v0
    v_lshl_add_u32 v14, v14, 2, v11
    s_mul_i32 s54, s45, 28672
    v_lshl_add_u32 v14, v14, 3, s54
    v_and_b32 v11, 2, v10
    v_lshl_add_u32 v10, v10, 7, v14
    v_lshl_add_u32 v10, v11, 5, v10
    v_xor_b32 v11, 64, v10
    v_and_b32 v13, 2, v12
    v_lshl_add_u32 v12, v12, 7, v14
    v_lshl_add_u32 v12, v13, 5, v12
    v_xor_b32 v13, 64, v12
    s_mul_i32 s53, s4, 3584
    v_add_u32 v24, s53, v10
    v_add_u32 v25, s53, v11
    v_add_u32 v26, s53, v12
    v_add_u32 v27, s53, v13
    ds_read_b64_tr_b16 v[128:129], v24 offset:0
    ds_read_b64_tr_b16 v[130:131], v26 offset:1024
    ds_read_b64_tr_b16 v[132:133], v25 offset:0
    ds_read_b64_tr_b16 v[134:135], v27 offset:1024
    ds_read_b64_tr_b16 v[136:137], v25 offset:1792
    ds_read_b64_tr_b16 v[138:139], v27 offset:2816
    ds_read_b64_tr_b16 v[140:141], v24 offset:1792
    ds_read_b64_tr_b16 v[142:143], v26 offset:2816
    v_mov_b32 v32, 0
    v_mov_b32 v33, 0
    v_mov_b32 v34, 0
    v_mov_b32 v35, 0
    v_mov_b32 v36, 0
    v_mov_b32 v37, 0
    v_mov_b32 v38, 0
    v_mov_b32 v39, 0
    v_mov_b32 v40, 0
    v_mov_b32 v41, 0
    v_mov_b32 v42, 0
    v_mov_b32 v43, 0
    v_mov_b32 v44, 0
    v_mov_b32 v45, 0
    v_mov_b32 v46, 0
    v_mov_b32 v47, 0
    v_mov_b32 v48, 0
    v_mov_b32 v49, 0
    v_mov_b32 v50, 0
    v_mov_b32 v51, 0
    v_mov_b32 v52, 0
    v_mov_b32 v53, 0
    v_mov_b32 v54, 0
    v_mov_b32 v55, 0
    v_mov_b32 v56, 0
    v_mov_b32 v57, 0
    v_mov_b32 v58, 0
    v_mov_b32 v59, 0
    v_mov_b32 v60, 0
    v_mov_b32 v61, 0
    v_mov_b32 v62, 0
    v_mov_b32 v63, 0
    s_mul_i32 s53, s5, 3584
    v_add_u32 v24, s53, v10
    v_add_u32 v25, s53, v11
    v_add_u32 v26, s53, v12
    v_add_u32 v27, s53, v13
    ds_read_b64_tr_b16 v[144:145], v24 offset:0
    ds_read_b64_tr_b16 v[146:147], v26 offset:1024
    ds_read_b64_tr_b16 v[148:149], v25 offset:0
    ds_read_b64_tr_b16 v[150:151], v27 offset:1024
    ds_read_b64_tr_b16 v[152:153], v25 offset:1792
    ds_read_b64_tr_b16 v[154:155], v27 offset:2816
    ds_read_b64_tr_b16 v[156:157], v24 offset:1792
    ds_read_b64_tr_b16 v[158:159], v26 offset:2816
    s_cmp_le_u32 s51, 0
    s_cbranch_scc1 L_t0
    s_cmp_le_u32 s51, 2
    s_cbranch_scc1 L_w0
    s_lshl_b32 s53, s6, 11
    s_add_u32 s53, s53, s59
    buffer_load_dwordx4 v[80:83], v5, s[28:31], s53 offen offset:0 sc1
    buffer_load_dwordx4 v[84:87], v5, s[28:31], s53 offen offset:1024 sc1
    s_waitcnt vmcnt(4)
    s_branch L_x0
L_w0:
    s_waitcnt vmcnt(0)
L_x0:
    s_waitcnt lgkmcnt(8)
    v_xor_b32 v67, v17, v67
    v_xor_b32 v71, v17, v71
    v_max_u32 v14, v67, v71
    v_cmp_le_u32 vcc, 0x10000, v14
    s_cbranch_vccnz L_t0
    s_bitset0_b32 s49, s4
    v_mfma_f32_32x32x16_bf16 v[32:47], v[128:131], v[64:67], v[32:47]
    v_mfma_f32_32x32x16_bf16 v[48:63], v[132:135], v[64:67], v[48:63]
    v_mfma_f32_32x32x16_bf16 v[32:47], v[136:139], v[68:71], v[32:47]
    v_mfma_f32_32x32x16_bf16 v[48:63], v[140:143], v[68:71], v[48:63]
L_t0:
    s_mul_i32 s53, s6, 3584
    v_add_u32 v24, s53, v10
    v_add_u32 v25, s53, v11
    v_add_u32 v26, s53, v12
    v_add_u32 v27, s53, v13
    ds_read_b64_tr_b16 v[160:161], v24 offset:0
    ds_read_b64_tr_b16 v[162:163], v26 offset:1024
    ds_read_b64_tr_b16 v[164:165], v25 offset:0
    ds_read_b64_tr_b16 v[166:167], v27 offset:1024
    ds_read_b64_tr_b16 v[168:169], v25 offset:1792
    ds_read_b64_tr_b16 v[170:171], v27 offset:2816
    ds_read_b64_tr_b16 v[172:173], v24 offset:1792
    ds_read_b64_tr_b16 v[174:175], v26 offset:2816
    s_cmp_le_u32 s51, 1
    s_cbranch_scc1 L_t1
    s_cmp_le_u32 s51, 3
    s_cbranch_scc1 L_w1
    s_lshl_b32 s53, s7, 11
    s_add_u32 s53, s53, s59
    buffer_load_dwordx4 v[88:91], v5, s[28:31], s53 offen offset:0 sc1
    buffer_load_dwordx4 v[92:95], v5, s[28:31], s53 offen offset:1024 sc1
    s_waitcnt vmcnt(4)
    s_branch L_x1
L_w1:
    s_waitcnt vmcnt(0)
L_x1:
    s_waitcnt lgkmcnt(8)
    v_xor_b32 v75, v17, v75
    v_xor_b32 v79, v17, v79
    v_max_u32 v14, v75, v79
    v_cmp_le_u32 vcc, 0x10000, v14
    s_cbranch_vccnz L_t1
    s_bitset0_b32 s49, s5
    v_mfma_f32_32x32x16_bf16 v[32:47], v[144:147], v[72:75], v[32:47]
    v_mfma_f32_32x32x16_bf16 v[48:63], v[148:151], v[72:75], v[48:63]
    v_mfma_f32_32x32x16_bf16 v[32:47], v[152:155], v[76:79], v[32:47]
    v_mfma_f32_32x32x16_bf16 v[48:63], v[156:159], v[76:79], v[48:63]
L_t1:
    s_mul_i32 s53, s7, 3584
    v_add_u32 v24, s53, v10
    v_add_u32 v25, s53, v11
    v_add_u32 v26, s53, v12
    v_add_u32 v27, s53, v13
    ds_read_b64_tr_b16 v[176:177], v24 offset:0
    ds_read_b64_tr_b16 v[178:179], v26 offset:1024
    ds_read_b64_tr_b16 v[180:181], v25 offset:0
    ds_read_b64_tr_b16 v[182:183], v27 offset:1024
    ds_read_b64_tr_b16 v[184:185], v25 offset:1792
    ds_read_b64_tr_b16 v[186:187], v27 offset:2816
    ds_read_b64_tr_b16 v[188:189], v24 offset:1792
    ds_read_b64_tr_b16 v[190:191], v26 offset:2816
    s_cmp_le_u32 s51, 2
    s_cbranch_scc1 L_t2
    s_cmp_le_u32 s51, 4
    s_cbranch_scc1 L_w2
    s_lshl_b32 s53, s8, 11
    s_add_u32 s53, s53, s59
    buffer_load_dwordx4 v[96:99], v5, s[28:31], s53 offen offset:0 sc1
    buffer_load_dwordx4 v[100:103], v5, s[28:31], s53 offen offset:1024 sc1
    s_waitcnt vmcnt(4)
    s_branch L_x2
L_w2:
    s_waitcnt vmcnt(0)
L_x2:
    s_waitcnt lgkmcnt(8)
    v_xor_b32 v83, v17, v83
    v_xor_b32 v87, v17, v87
    v_max_u32 v14, v83, v87
    v_cmp_le_u32 vcc, 0x10000, v14
    s_cbranch_vccnz L_t2
    s_bitset0_b32 s49, s6
    v_mfma_f32_32x32x16_bf16 v[32:47], v[160:163], v[80:83], v[32:47]
    v_mfma_f32_32x32x16_bf16 v[48:63], v[164:167], v[80:83], v[48:63]
    v_mfma_f32_32x32x16_bf16 v[32:47], v[168:171], v[84:87], v[32:47]
    v_mfma_f32_32x32x16_bf16 v[48:63], v[172:175], v[84:87], v[48:63]
L_t2:
    s_mul_i32 s53, s8, 3584
    v_add_u32 v24, s53, v10
    v_add_u32 v25, s53, v11
    v_add_u32 v26, s53, v12
    v_add_u32 v27, s53, v13
    ds_read_b64_tr_b16 v[192:193], v24 offset:0
    ds_read_b64_tr_b16 v[194:195], v26 offset:1024
    ds_read_b64_tr_b16 v[196:197], v25 offset:0
    ds_read_b64_tr_b16 v[198:199], v27 offset:1024
    ds_read_b64_tr_b16 v[200:201], v25 offset:1792
    ds_read_b64_tr_b16 v[202:203], v27 offset:2816
    ds_read_b64_tr_b16 v[204:205], v24 offset:1792
    ds_read_b64_tr_b16 v[206:207], v26 offset:2816
    s_cmp_le_u32 s51, 3
    s_cbranch_scc1 L_t3
    s_cmp_le_u32 s51, 5
    s_cbranch_scc1 L_w3
    s_lshl_b32 s53, s9, 11
    s_add_u32 s53, s53, s59
    buffer_load_dwordx4 v[104:107], v5, s[28:31], s53 offen offset:0 sc1
    buffer_load_dwordx4 v[108:111], v5, s[28:31], s53 offen offset:1024 sc1
    s_waitcnt vmcnt(4)
    s_branch L_x3
L_w3:
    s_waitcnt vmcnt(0)
L_x3:
    s_waitcnt lgkmcnt(8)
    v_xor_b32 v91, v17, v91
    v_xor_b32 v95, v17, v95
    v_max_u32 v14, v91, v95
    v_cmp_le_u32 vcc, 0x10000, v14
    s_cbranch_vccnz L_t3
    s_bitset0_b32 s49, s7
    v_mfma_f32_32x32x16_bf16 v[32:47], v[176:179], v[88:91], v[32:47]
    v_mfma_f32_32x32x16_bf16 v[48:63], v[180:183], v[88:91], v[48:63]
    v_mfma_f32_32x32x16_bf16 v[32:47], v[184:187], v[92:95], v[32:47]
    v_mfma_f32_32x32x16_bf16 v[48:63], v[188:191], v[92:95], v[48:63]
L_t3:
    s_mul_i32 s53, s9, 3584
    v_add_u32 v24, s53, v10
    v_add_u32 v25, s53, v11
    v_add_u32 v26, s53, v12
    v_add_u32 v27, s53, v13
    ds_read_b64_tr_b16 v[208:209], v24 offset:0
    ds_read_b64_tr_b16 v[210:211], v26 offset:1024
    ds_read_b64_tr_b16 v[212:213], v25 offset:0
    ds_read_b64_tr_b16 v[214:215], v27 offset:1024
    ds_read_b64_tr_b16 v[216:217], v25 offset:1792
    ds_read_b64_tr_b16 v[218:219], v27 offset:2816
    ds_read_b64_tr_b16 v[220:221], v24 offset:1792
    ds_read_b64_tr_b16 v[222:223], v26 offset:2816
    s_cmp_le_u32 s51, 4
    s_cbranch_scc1 L_t4
    s_cmp_le_u32 s51, 6
    s_cbranch_scc1 L_w4
    s_lshl_b32 s53, s10, 11
    s_add_u32 s53, s53, s59
    buffer_load_dwordx4 v[112:115], v5, s[28:31], s53 offen offset:0 sc1
    buffer_load_dwordx4 v[116:119], v5, s[28:31], s53 offen offset:1024 sc1
    s_waitcnt vmcnt(4)
    s_branch L_x4
L_w4:
    s_waitcnt vmcnt(0)
L_x4:
    s_waitcnt lgkmcnt(8)
    v_xor_b32 v99, v17, v99
    v_xor_b32 v103, v17, v103
    v_max_u32 v14, v99, v103
    v_cmp_le_u32 vcc, 0x10000, v14
    s_cbranch_vccnz L_t4
    s_bitset0_b32 s49, s8
    v_mfma_f32_32x32x16_bf16 v[32:47], v[192:195], v[96:99], v[32:47]
    v_mfma_f32_32x32x16_bf16 v[48:63], v[196:199], v[96:99], v[48:63]
    v_mfma_f32_32x32x16_bf16 v[32:47], v[200:203], v[100:103], v[32:47]
    v_mfma_f32_32x32x16_bf16 v[48:63], v[204:207], v[100:103], v[48:63]
L_t4:
    s_mul_i32 s53, s10, 3584
    v_add_u32 v24, s53, v10
    v_add_u32 v25, s53, v11
    v_add_u32 v26, s53, v12
    v_add_u32 v27, s53, v13
    ds_read_b64_tr_b16 v[224:225], v24 offset:0
    ds_read_b64_tr_b16 v[226:227], v26 offset:1024
    ds_read_b64_tr_b16 v[228:229], v25 offset:0
    ds_read_b64_tr_b16 v[230:231], v27 offset:1024
    ds_read_b64_tr_b16 v[232:233], v25 offset:1792
    ds_read_b64_tr_b16 v[234:235], v27 offset:2816
    ds_read_b64_tr_b16 v[236:237], v24 offset:1792
    ds_read_b64_tr_b16 v[238:239], v26 offset:2816
    s_cmp_le_u32 s51, 5
    s_cbranch_scc1 L_t5
    s_cmp_le_u32 s51, 7
    s_cbranch_scc1 L_w5
    s_lshl_b32 s53, s11, 11
    s_add_u32 s53, s53, s59
    buffer_load_dwordx4 v[120:123], v5, s[28:31], s53 offen offset:0 sc1
    buffer_load_dwordx4 v[124:127], v5, s[28:31], s53 offen offset:1024 sc1
    s_waitcnt vmcnt(4)
    s_branch L_x5
L_w5:
    s_waitcnt vmcnt(0)
L_x5:
    s_waitcnt lgkmcnt(8)
    v_xor_b32 v107, v17, v107
    v_xor_b32 v111, v17, v111
    v_max_u32 v14, v107, v111
    v_cmp_le_u32 vcc, 0x10000, v14
    s_cbranch_vccnz L_t5
    s_bitset0_b32 s49, s9
    v_mfma_f32_32x32x16_bf16 v[32:47], v[208:211], v[104:107], v[32:47]
    v_mfma_f32_32x32x16_bf16 v[48:63], v[212:215], v[104:107], v[48:63]
    v_mfma_f32_32x32x16_bf16 v[32:47], v[216:219], v[108:111], v[32:47]
    v_mfma_f32_32x32x16_bf16 v[48:63], v[220:223], v[108:111], v[48:63]
L_t5:
    s_mul_i32 s53, s11, 3584
    v_add_u32 v24, s53, v10
    v_add_u32 v25, s53, v11
    v_add_u32 v26, s53, v12
    v_add_u32 v27, s53, v13
    ds_read_b64_tr_b16 v[240:241], v24 offset:0
    ds_read_b64_tr_b16 v[242:243], v26 offset:1024
    ds_read_b64_tr_b16 v[244:245], v25 offset:0
    ds_read_b64_tr_b16 v[246:247], v27 offset:1024
    ds_read_b64_tr_b16 v[248:249], v25 offset:1792
    ds_read_b64_tr_b16 v[250:251], v27 offset:2816
    ds_read_b64_tr_b16 v[252:253], v24 offset:1792
    ds_read_b64_tr_b16 v[254:255], v26 offset:2816
    s_cmp_le_u32 s51, 6
    s_cbranch_scc1 L_t6
    s_waitcnt vmcnt(2)
    s_waitcnt lgkmcnt(8)
    v_xor_b32 v115, v17, v115
    v_xor_b32 v119, v17, v119
    v_max_u32 v14, v115, v119
    v_cmp_le_u32 vcc, 0x10000, v14
    s_cbranch_vccnz L_t6
    s_bitset0_b32 s49, s10
    v_mfma_f32_32x32x16_bf16 v[32:47], v[224:227], v[112:115], v[32:47]
    v_mfma_f32_32x32x16_bf16 v[48:63], v[228:231], v[112:115], v[48:63]
    v_mfma_f32_32x32x16_bf16 v[32:47], v[232:235], v[116:119], v[32:47]
    v_mfma_f32_32x32x16_bf16 v[48:63], v[236:239], v[116:119], v[48:63]
L_t6:
    s_cmp_le_u32 s51, 7
    s_cbranch_scc1 L_t7
    s_waitcnt vmcnt(0)
    s_waitcnt lgkmcnt(0)
    v_xor_b32 v123, v17, v123
    v_xor_b32 v127, v17, v127
    v_max_u32 v14, v123, v127
    v_cmp_le_u32 vcc, 0x10000, v14
    s_cbranch_vccnz L_t7
    s_bitset0_b32 s49, s11
    v_mfma_f32_32x32x16_bf16 v[32:47], v[240:243], v[120:123], v[32:47]
    v_mfma_f32_32x32x16_bf16 v[48:63], v[244:247], v[120:123], v[48:63]
    v_mfma_f32_32x32x16_bf16 v[32:47], v[248:251], v[124:127], v[32:47]
    v_mfma_f32_32x32x16_bf16 v[48:63], v[252:255], v[124:127], v[48:63]
L_t7:
L_round:
    s_cmp_eq_u32 s49, 0
    s_cbranch_scc1 L_gpoll
    s_mov_b64 exec, 0xff
    buffer_load_ushort v21, v8, s[28:31], s59 offen offset:2046 sc1
    s_mov_b64 exec, -1
    s_sub_u32 s60, s60, 1
    s_cbranch_scc1 L_gdone
    s_waitcnt vmcnt(0) lgkmcnt(0)
    v_cmp_eq_u32 vcc, s43, v21
    s_and_b32 s50, vcc_lo, s49
    s_cbranch_scc0 L_round
    s_bitcmp1_b32 s50, s4
    s_cbranch_scc0 L_l0
    s_lshl_b32 s53, s4, 11
    s_add_u32 s53, s53, s59
    buffer_load_dwordx4 v[64:67], v5, s[28:31], s53 offen offset:0 sc1
    buffer_load_dwordx4 v[68:71], v5, s[28:31], s53 offen offset:1024 sc1
L_l0:
    s_bitcmp1_b32 s50, s5
    s_cbranch_scc0 L_l1
    s_lshl_b32 s53, s5, 11
    s_add_u32 s53, s53, s59
    buffer_load_dwordx4 v[72:75], v5, s[28:31], s53 offen offset:0 sc1
    buffer_load_dwordx4 v[76:79], v5, s[28:31], s53 offen offset:1024 sc1
L_l1:
    s_bitcmp1_b32 s50, s6
    s_cbranch_scc0 L_l2
    s_lshl_b32 s53, s6, 11
    s_add_u32 s53, s53, s59
    buffer_load_dwordx4 v[80:83], v5, s[28:31], s53 offen offset:0 sc1
    buffer_load_dwordx4 v[84:87], v5, s[28:31], s53 offen offset:1024 sc1
L_l2:
    s_bitcmp1_b32 s50, s7
    s_cbranch_scc0 L_l3
    s_lshl_b32 s53, s7, 11
    s_add_u32 s53, s53, s59
    buffer_load_dwordx4 v[88:91], v5, s[28:31], s53 offen offset:0 sc1
    buffer_load_dwordx4 v[92:95], v5, s[28:31], s53 offen offset:1024 sc1
L_l3:
    s_bitcmp1_b32 s50, s8
    s_cbranch_scc0 L_l4
    s_lshl_b32 s53, s8, 11
    s_add_u32 s53, s53, s59
    buffer_load_dwordx4 v[96:99], v5, s[28:31], s53 offen offset:0 sc1
    buffer_load_dwordx4 v[100:103], v5, s[28:31], s53 offen offset:1024 sc1
L_l4:
    s_bitcmp1_b32 s50, s9
    s_cbranch_scc0 L_l5
    s_lshl_b32 s53, s9, 11
    s_add_u32 s53, s53, s59
    buffer_load_dwordx4 v[104:107], v5, s[28:31], s53 offen offset:0 sc1
    buffer_load_dwordx4 v[108:111], v5, s[28:31], s53 offen offset:1024 sc1
L_l5:
    s_bitcmp1_b32 s50, s10
    s_cbranch_scc0 L_l6
    s_lshl_b32 s53, s10, 11
    s_add_u32 s53, s53, s59
    buffer_load_dwordx4 v[112:115], v5, s[28:31], s53 offen offset:0 sc1
    buffer_load_dwordx4 v[116:119], v5, s[28:31], s53 offen offset:1024 sc1
L_l6:
    s_bitcmp1_b32 s50, s11
    s_cbranch_scc0 L_l7
    s_lshl_b32 s53, s11, 11
    s_add_u32 s53, s53, s59
    buffer_load_dwordx4 v[120:123], v5, s[28:31], s53 offen offset:0 sc1
    buffer_load_dwordx4 v[124:127], v5, s[28:31], s53 offen offset:1024 sc1
L_l7:
    s_waitcnt vmcnt(0)
    s_bitcmp1_b32 s50, s4
    s_cbranch_scc0 L_u0
    v_xor_b32 v67, v17, v67
    v_xor_b32 v71, v17, v71
    v_max_u32 v14, v67, v71
    v_cmp_le_u32 vcc, 0x10000, v14
    s_cbranch_vccnz L_u0
    s_bitset0_b32 s49, s4
    v_mfma_f32_32x32x16_bf16 v[32:47], v[128:131], v[64:67], v[32:47]
    v_mfma_f32_32x32x16_bf16 v[48:63], v[132:135], v[64:67], v[48:63]
    v_mfma_f32_32x32x16_bf16 v[32:47], v[136:139], v[68:71], v[32:47]
    v_mfma_f32_32x32x16_bf16 v[48:63], v[140:143], v[68:71], v[48:63]
L_u0:
    s_bitcmp1_b32 s50, s5
    s_cbranch_scc0 L_u1
    v_xor_b32 v75, v17, v75
    v_xor_b32 v79, v17, v79
    v_max_u32 v14, v75, v79
    v_cmp_le_u32 vcc, 0x10000, v14
    s_cbranch_vccnz L_u1
    s_bitset0_b32 s49, s5
    v_mfma_f32_32x32x16_bf16 v[32:47], v[144:147], v[72:75], v[32:47]
    v_mfma_f32_32x32x16_bf16 v[48:63], v[148:151], v[72:75], v[48:63]
    v_mfma_f32_32x32x16_bf16 v[32:47], v[152:155], v[76:79], v[32:47]
    v_mfma_f32_32x32x16_bf16 v[48:63], v[156:159], v[76:79], v[48:63]
L_u1:
    s_bitcmp1_b32 s50, s6
    s_cbranch_scc0 L_u2
    v_xor_b32 v83, v17, v83
    v_xor_b32 v87, v17, v87
    v_max_u32 v14, v83, v87
    v_cmp_le_u32 vcc, 0x10000, v14
    s_cbranch_vccnz L_u2
    s_bitset0_b32 s49, s6
    v_mfma_f32_32x32x16_bf16 v[32:47], v[160:163], v[80:83], v[32:47]
    v_mfma_f32_32x32x16_bf16 v[48:63], v[164:167], v[80:83], v[48:63]
    v_mfma_f32_32x32x16_bf16 v[32:47], v[168:171], v[84:87], v[32:47]
    v_mfma_f32_32x32x16_bf16 v[48:63], v[172:175], v[84:87], v[48:63]
L_u2:
    s_bitcmp1_b32 s50, s7
    s_cbranch_scc0 L_u3
    v_xor_b32 v91, v17, v91
    v_xor_b32 v95, v17, v95
    v_max_u32 v14, v91, v95
    v_cmp_le_u32 vcc, 0x10000, v14
    s_cbranch_vccnz L_u3
    s_bitset0_b32 s49, s7
    v_mfma_f32_32x32x16_bf16 v[32:47], v[176:179], v[88:91], v[32:47]
    v_mfma_f32_32x32x16_bf16 v[48:63], v[180:183], v[88:91], v[48:63]
    v_mfma_f32_32x32x16_bf16 v[32:47], v[184:187], v[92:95], v[32:47]
    v_mfma_f32_32x32x16_bf16 v[48:63], v[188:191], v[92:95], v[48:63]
L_u3:
    s_bitcmp1_b32 s50, s8
    s_cbranch_scc0 L_u4
    v_xor_b32 v99, v17, v99
    v_xor_b32 v103, v17, v103
    v_max_u32 v14, v99, v103
    v_cmp_le_u32 vcc, 0x10000, v14
    s_cbranch_vccnz L_u4
    s_bitset0_b32 s49, s8
    v_mfma_f32_32x32x16_bf16 v[32:47], v[192:195], v[96:99], v[32:47]
    v_mfma_f32_32x32x16_bf16 v[48:63], v[196:199], v[96:99], v[48:63]
    v_mfma_f32_32x32x16_bf16 v[32:47], v[200:203], v[100:103], v[32:47]
    v_mfma_f32_32x32x16_bf16 v[48:63], v[204:207], v[100:103], v[48:63]
L_u4:
    s_bitcmp1_b32 s50, s9
    s_cbranch_scc0 L_u5
    v_xor_b32 v107, v17, v107
    v_xor_b32 v111, v17, v111
    v_max_u32 v14, v107, v111
    v_cmp_le_u32 vcc, 0x10000, v14
    s_cbranch_vccnz L_u5
    s_bitset0_b32 s49, s9
    v_mfma_f32_32x32x16_bf16 v[32:47], v[208:211], v[104:107], v[32:47]
    v_mfma_f32_32x32x16_bf16 v[48:63], v[212:215], v[104:107], v[48:63]
    v_mfma_f32_32x32x16_bf16 v[32:47], v[216:219], v[108:111], v[32:47]
    v_mfma_f32_32x32x16_bf16 v[48:63], v[220:223], v[108:111], v[48:63]
L_u5:
    s_bitcmp1_b32 s50, s10
    s_cbranch_scc0 L_u6
    v_xor_b32 v115, v17, v115
    v_xor_b32 v119, v17, v119
    v_max_u32 v14, v115, v119
    v_cmp_le_u32 vcc, 0x10000, v14
    s_cbranch_vccnz L_u6
    s_bitset0_b32 s49, s10
    v_mfma_f32_32x32x16_bf16 v[32:47], v[224:227], v[112:115], v[32:47]
    v_mfma_f32_32x32x16_bf16 v[48:63], v[228:231], v[112:115], v[48:63]
    v_mfma_f32_32x32x16_bf16 v[32:47], v[232:235], v[116:119], v[32:47]
    v_mfma_f32_32x32x16_bf16 v[48:63], v[236:239], v[116:119], v[48:63]
L_u6:
    s_bitcmp1_b32 s50, s11
    s_cbranch_scc0 L_u7
    v_xor_b32 v123, v17, v123
    v_xor_b32 v127, v17, v127
    v_max_u32 v14, v123, v127
    v_cmp_le_u32 vcc, 0x10000, v14
    s_cbranch_vccnz L_u7
    s_bitset0_b32 s49, s11
    v_mfma_f32_32x32x16_bf16 v[32:47], v[240:243], v[120:123], v[32:47]
    v_mfma_f32_32x32x16_bf16 v[48:63], v[244:247], v[120:123], v[48:63]
    v_mfma_f32_32x32x16_bf16 v[32:47], v[248:251], v[124:127], v[32:47]
    v_mfma_f32_32x32x16_bf16 v[48:63], v[252:255], v[124:127], v[48:63]
L_u7:
    s_branch L_round
L_gagain:
    buffer_load_dwordx2 v[22:23], v7, s[28:31], s47 offen sc1
    s_sub_u32 s60, s60, 1
    s_cbranch_scc1 L_gdone
L_gpoll:
    s_waitcnt vmcnt(0)
    v_cmp_ne_u32 vcc, s67, v23
    s_cbranch_vccnz L_gagain
L_gdone:
    s_waitcnt vmcnt(0)
    v_sub_f32 v13, 1.0, v22
    s_cmp_ge_u32 s42, 4
    s_cselect_b64 vcc, -1, 0
    s_mul_i32 s54, s44, 24576
    s_add_u32 s54, s54, 114688
    v_add_u32 v14, s54, v5
    s_mul_i32 s55, s45, 6144
    v_cndmask_b32 v12, v22, v13, vcc
    v_add_u32 v16, s55, v14
    v_mul_u32_u24 v15, 896, v6
    v_lshl_add_u32 v15, v18, 4, v15
    s_mul_i32 s54, s46, 28672
    s_lshl_b32 s55, s62, 7
    s_add_u32 s54, s54, s55
    s_lshl_b32 s55, s45, 5
    s_add_u32 s54, s54, s55
    s_cmp_eq_u32 s45, 1
    s_cbranch_scc1 L_r1
    s_cmp_eq_u32 s45, 2
    s_cbranch_scc1 L_r2
    s_cmp_eq_u32 s45, 3
    s_cbranch_scc1 L_r3
L_r0:
    v_pk_mul_f32 v[40:41], v[40:41], v[12:13] op_sel_hi:[1,0]
    v_pk_mul_f32 v[42:43], v[42:43], v[12:13] op_sel_hi:[1,0]
    v_pk_mul_f32 v[44:45], v[44:45], v[12:13] op_sel_hi:[1,0]
    v_pk_mul_f32 v[46:47], v[46:47], v[12:13] op_sel_hi:[1,0]
    ds_write_b128 v14, v[40:43] offset:10240
    ds_write_b128 v14, v[44:47] offset:11264
    v_pk_mul_f32 v[48:49], v[48:49], v[12:13] op_sel_hi:[1,0]
    v_pk_mul_f32 v[50:51], v[50:51], v[12:13] op_sel_hi:[1,0]
    v_pk_mul_f32 v[52:53], v[52:53], v[12:13] op_sel_hi:[1,0]
    v_pk_mul_f32 v[54:55], v[54:55], v[12:13] op_sel_hi:[1,0]
    ds_write_b128 v14, v[48:51] offset:14336
    ds_write_b128 v14, v[52:55] offset:15360
    v_pk_mul_f32 v[56:57], v[56:57], v[12:13] op_sel_hi:[1,0]
    v_pk_mul_f32 v[58:59], v[58:59], v[12:13] op_sel_hi:[1,0]
    v_pk_mul_f32 v[60:61], v[60:61], v[12:13] op_sel_hi:[1,0]
    v_pk_mul_f32 v[62:63], v[62:63], v[12:13] op_sel_hi:[1,0]
    ds_write_b128 v14, v[56:59] offset:18432
    ds_write_b128 v14, v[60:63] offset:19456
    v_pk_mul_f32 v[64:65], v[32:33], v[12:13] op_sel_hi:[1,0]
    v_pk_mul_f32 v[66:67], v[34:35], v[12:13] op_sel_hi:[1,0]
    v_pk_mul_f32 v[68:69], v[36:37], v[12:13] op_sel_hi:[1,0]
    v_pk_mul_f32 v[70:71], v[38:39], v[12:13] op_sel_hi:[1,0]
    s_branch L_rd
L_r1:
    v_pk_mul_f32 v[32:33], v[32:33], v[12:13] op_sel_hi:[1,0]
    v_pk_mul_f32 v[34:35], v[34:35], v[12:13] op_sel_hi:[1,0]
    v_pk_mul_f32 v[36:37], v[36:37], v[12:13] op_sel_hi:[1,0]
    v_pk_mul_f32 v[38:39], v[38:39], v[12:13] op_sel_hi:[1,0]
    ds_write_b128 v14, v[32:35] offset:0
    ds_write_b128 v14, v[36:39] offset:1024
    v_pk_mul_f32 v[48:49], v[48:49], v[12:13] op_sel_hi:[1,0]
    v_pk_mul_f32 v[50:51], v[50:51], v[12:13] op_sel_hi:[1,0]
    v_pk_mul_f32 v[52:53], v[52:53], v[12:13] op_sel_hi:[1,0]
    v_pk_mul_f32 v[54:55], v[54:55], v[12:13] op_sel_hi:[1,0]
    ds_write_b128 v14, v[48:51] offset:16384
    ds_write_b128 v14, v[52:55] offset:17408
    v_pk_mul_f32 v[56:57], v[56:57], v[12:13] op_sel_hi:[1,0]
    v_pk_mul_f32 v[58:59], v[58:59], v[12:13] op_sel_hi:[1,0]
    v_pk_mul_f32 v[60:61], v[60:61], v[12:13] op_sel_hi:[1,0]
    v_pk_mul_f32 v[62:63], v[62:63], v[12:13] op_sel_hi:[1,0]
    ds_write_b128 v14, v[56:59] offset:20480
    ds_write_b128 v14, v[60:63] offset:21504
    v_pk_mul_f32 v[64:65], v[40:41], v[12:13] op_sel_hi:[1,0]
    v_pk_mul_f32 v[66:67], v[42:43], v[12:13] op_sel_hi:[1,0]
    v_pk_mul_f32 v[68:69], v[44:45], v[12:13] op_sel_hi:[1,0]
    v_pk_mul_f32 v[70:71], v[46:47], v[12:13] op_sel_hi:[1,0]
    s_branch L_rd
L_r2:
    v_pk_mul_f32 v[32:33], v[32:33], v[12:13] op_sel_hi:[1,0]
    v_pk_mul_f32 v[34:35], v[34:35], v[12:13] op_sel_hi:[1,0]
    v_pk_mul_f32 v[36:37], v[36:37], v[12:13] op_sel_hi:[1,0]
    v_pk_mul_f32 v[38:39], v[38:39], v[12:13] op_sel_hi:[1,0]
    ds_write_b128 v14, v[32:35] offset:2048
    ds_write_b128 v14, v[36:39] offset:3072
    v_pk_mul_f32 v[40:41], v[40:41], v[12:13] op_sel_hi:[1,0]
    v_pk_mul_f32 v[42:43], v[42:43], v[12:13] op_sel_hi:[1,0]
    v_pk_mul_f32 v[44:45], v[44:45], v[12:13] op_sel_hi:[1,0]
    v_pk_mul_f32 v[46:47], v[46:47], v[12:13] op_sel_hi:[1,0]
    ds_write_b128 v14, v[40:43] offset:6144
    ds_write_b128 v14, v[44:47] offset:7168
    v_pk_mul_f32 v[56:57], v[56:57], v[12:13] op_sel_hi:[1,0]
    v_pk_mul_f32 v[58:59], v[58:59], v[12:13] op_sel_hi:[1,0]
    v_pk_mul_f32 v[60:61], v[60:61], v[12:13] op_sel_hi:[1,0]
    v_pk_mul_f32 v[62:63], v[62:63], v[12:13] op_sel_hi:[1,0]
    ds_write_b128 v14, v[56:59] offset:22528
    ds_write_b128 v14, v[60:63] offset:23552
    v_pk_mul_f32 v[64:65], v[48:49], v[12:13] op_sel_hi:[1,0]
    v_pk_mul_f32 v[66:67], v[50:51], v[12:13] op_sel_hi:[1,0]
    v_pk_mul_f32 v[68:69], v[52:53], v[12:13] op_sel_hi:[1,0]
    v_pk_mul_f32 v[70:71], v[54:55], v[12:13] op_sel_hi:[1,0]
    s_branch L_rd
L_r3:
    v_pk_mul_f32 v[32:33], v[32:33], v[12:13] op_sel_hi:[1,0]
    v_pk_mul_f32 v[34:35], v[34:35], v[12:13] op_sel_hi:[1,0]
    v_pk_mul_f32 v[36:37], v[36:37], v[12:13] op_sel_hi:[1,0]
    v_pk_mul_f32 v[38:39], v[38:39], v[12:13] op_sel_hi:[1,0]
    ds_write_b128 v14, v[32:35] offset:4096
    ds_write_b128 v14, v[36:39] offset:5120
    v_pk_mul_f32 v[40:41], v[40:41], v[12:13] op_sel_hi:[1,0]
    v_pk_mul_f32 v[42:43], v[42:43], v[12:13] op_sel_hi:[1,0]
    v_pk_mul_f32 v[44:45], v[44:45], v[12:13] op_sel_hi:[1,0]
    v_pk_mul_f32 v[46:47], v[46:47], v[12:13] op_sel_hi:[1,0]
    ds_write_b128 v14, v[40:43] offset:8192
    ds_write_b128 v14, v[44:47] offset:9216
    v_pk_mul_f32 v[48:49], v[48:49], v[12:13] op_sel_hi:[1,0]
    v_pk_mul_f32 v[50:51], v[50:51], v[12:13] op_sel_hi:[1,0]
    v_pk_mul_f32 v[52:53], v[52:53], v[12:13] op_sel_hi:[1,0]
    v_pk_mul_f32 v[54:55], v[54:55], v[12:13] op_sel_hi:[1,0]
    ds_write_b128 v14, v[48:51] offset:12288
    ds_write_b128 v14, v[52:55] offset:13312
    v_pk_mul_f32 v[64:65], v[56:57], v[12:13] op_sel_hi:[1,0]
    v_pk_mul_f32 v[66:67], v[58:59], v[12:13] op_sel_hi:[1,0]
    v_pk_mul_f32 v[68:69], v[60:61], v[12:13] op_sel_hi:[1,0]
    v_pk_mul_f32 v[70:71], v[62:63], v[12:13] op_sel_hi:[1,0]
L_rd:
    s_waitcnt lgkmcnt(0)
    s_barrier
    ds_read_b128 v[72:75], v16 offset:0
    ds_read_b128 v[76:79], v16 offset:1024
    ds_read_b128 v[80:83], v16 offset:2048
    ds_read_b128 v[84:87], v16 offset:3072
    ds_read_b128 v[88:91], v16 offset:4096
    ds_read_b128 v[92:95], v16 offset:5120
    s_waitcnt lgkmcnt(4)
    v_pk_add_f32 v[64:65], v[64:65], v[72:73]
    v_pk_add_f32 v[66:67], v[66:67], v[74:75]
    v_pk_add_f32 v[68:69], v[68:69], v[76:77]
    v_pk_add_f32 v[70:71], v[70:71], v[78:79]
    s_waitcnt lgkmcnt(2)
    v_pk_add_f32 v[64:65], v[64:65], v[80:81]
    v_pk_add_f32 v[66:67], v[66:67], v[82:83]
    v_pk_add_f32 v[68:69], v[68:69], v[84:85]
    v_pk_add_f32 v[70:71], v[70:71], v[86:87]
    s_waitcnt lgkmcnt(0)
    v_pk_add_f32 v[64:65], v[64:65], v[88:89]
    v_pk_add_f32 v[66:67], v[66:67], v[90:91]
    v_pk_add_f32 v[68:69], v[68:69], v[92:93]
    v_pk_add_f32 v[70:71], v[70:71], v[94:95]
    v_cvt_pk_bf16_f32 v96, v64, v65
    v_cvt_pk_bf16_f32 v97, v66, v67
    v_cvt_pk_bf16_f32 v98, v68, v69
    v_cvt_pk_bf16_f32 v99, v70, v71
    s_nop 1
    v_permlane32_swap_b32 v96, v98
    v_permlane32_swap_b32 v97, v99
    buffer_store_dwordx4 v[96:99], v15, s[32:35], s54 offen
    s_or_b32 s53, s2, s42
    s_cmp_lg_u32 s53, 0
    s_cbranch_scc1 L_end
    s_mov_b32 s53, 12976128
    s_mov_b64 exec, 1
    buffer_store_dword v20, v31, s[28:31], s53 offen sc1
L_end:
    s_endpgm
L_fallback:
    v_mov_b32 v10, 0xff800000
    s_mov_b32 s56, s46
    s_add_u32 s57, s46, 262144
L_fb1:
    buffer_load_dwordx4 v[144:147], v5, s[28:31], s56 offen sc1
    buffer_load_dwordx4 v[148:151], v5, s[28:31], s56 offen offset:1024 sc1
    s_waitcnt vmcnt(0)
    v_mfma_f32_32x32x16_bf16 v[48:63], v[144:147], v[136:139], 0
    v_mfma_f32_32x32x16_bf16 v[48:63], v[148:151], v[140:143], v[48:63]
    s_nop 15
    v_max3_f32 v10, v48, v49, v10
    v_max3_f32 v10, v50, v51, v10
    v_max3_f32 v10, v52, v53, v10
    v_max3_f32 v10, v54, v55, v10
    v_max3_f32 v10, v56, v57, v10
    v_max3_f32 v10, v58, v59, v10
    v_max3_f32 v10, v60, v61, v10
    v_max3_f32 v10, v62, v63, v10
    s_add_u32 s56, s56, 4096
    s_cmp_lt_u32 s56, s57
    s_cbranch_scc1 L_fb1
    v_mov_b32 v11, v10
    s_nop 1
    v_permlane32_swap_b32 v10, v11
    s_nop 1
    v_max_f32 v10, v10, v11
    v_sub_f32 v64, 0, v10
    v_mov_b32 v32, 0
    v_sub_f32 v65, 0, v10
    v_mov_b32 v33, 0
    v_sub_f32 v66, 0, v10
    v_mov_b32 v34, 0
    v_sub_f32 v67, 0, v10
    v_mov_b32 v35, 0
    v_sub_f32 v68, 0, v10
    v_mov_b32 v36, 0
    v_sub_f32 v69, 0, v10
    v_mov_b32 v37, 0
    v_sub_f32 v70, 0, v10
    v_mov_b32 v38, 0
    v_sub_f32 v71, 0, v10
    v_mov_b32 v39, 0
    v_sub_f32 v72, 0, v10
    v_mov_b32 v40, 0
    v_sub_f32 v73, 0, v10
    v_mov_b32 v41, 0
    v_sub_f32 v74, 0, v10
    v_mov_b32 v42, 0
    v_sub_f32 v75, 0, v10
    v_mov_b32 v43, 0
    v_sub_f32 v76, 0, v10
    v_mov_b32 v44, 0
    v_sub_f32 v77, 0, v10
    v_mov_b32 v45, 0
    v_sub_f32 v78, 0, v10
    v_mov_b32 v46, 0
    v_sub_f32 v79, 0, v10
    v_mov_b32 v47, 0
    s_mov_b32 s56, s46
L_fb2:
    buffer_load_dwordx4 v[144:147], v5, s[28:31], s56 offen sc1
    buffer_load_dwordx4 v[148:151], v5, s[28:31], s56 offen offset:1024 sc1
    buffer_load_dwordx4 v[160:163], v5, s[28:31], s56 offen offset:2048 sc1
    buffer_load_dwordx4 v[164:167], v5, s[28:31], s56 offen offset:3072 sc1
    s_waitcnt vmcnt(0)
    v_mfma_f32_32x32x16_bf16 v[48:63], v[144:147], v[136:139], v[64:79]
    v_mfma_f32_32x32x16_bf16 v[48:63], v[148:151], v[140:143], v[48:63]
    s_nop 15
    v_exp_f32 v48, v48
    v_exp_f32 v49, v49
    v_exp_f32 v50, v50
    v_exp_f32 v51, v51
    v_exp_f32 v52, v52
    v_exp_f32 v53, v53
    v_exp_f32 v54, v54
    v_exp_f32 v55, v55
    v_exp_f32 v56, v56
    v_exp_f32 v57, v57
    v_exp_f32 v58, v58
    v_exp_f32 v59, v59
    v_exp_f32 v60, v60
    v_exp_f32 v61, v61
    v_exp_f32 v62, v62
    v_exp_f32 v63, v63
    s_nop 1
    v_smfmac_f32_32x32x32_bf16 v[32:47], v[160:163], v[48:55], v1
    v_smfmac_f32_32x32x32_bf16 v[32:47], v[164:167], v[56:63], v1
    s_add_u32 s56, s56, 4096
    s_cmp_lt_u32 s56, s57
    s_cbranch_scc1 L_fb2
    s_nop 15
    s_branch L_fin
.section .rodata,"a"
.p2align 6
.amdhsa_kernel gated_mix__mha_block__mha_block__prompt_kernel
  .amdhsa_next_free_vgpr 256
  .amdhsa_next_free_sgpr 102
  .amdhsa_accum_offset 256
  .amdhsa_group_segment_fixed_size 0
  .amdhsa_kernarg_size 80
  .amdhsa_user_sgpr_count 2
  .amdhsa_user_sgpr_kernarg_segment_ptr 1
  .amdhsa_system_sgpr_workgroup_id_x 1
  .amdhsa_float_denorm_mode_32 3
.end_amdhsa_kernel
```
